```python
import torch

def _softmax(x, axis=-1):
    return torch.softmax(x, dim=axis)
def _gelu(x):
    return torch.nn.functional.gelu(x, approximate="tanh")
def _silu(x):
    return torch.nn.functional.silu(x)
def _sigmoid(x):
    return torch.sigmoid(x)
def _layernorm(x, axis=-1, eps=1e-5):
    m = x.mean(dim=axis, keepdim=True)
    v = x.var(dim=axis, keepdim=True, unbiased=False)
    return (x - m) / torch.sqrt(v + eps)
def _scatter_add(tgt, idx, src, axis=0):
    return tgt.clone().index_add_(axis, idx, src)
def _segment_sum(src, seg, n):
    out = torch.zeros((n,) + src.shape[1:], dtype=src.dtype)
    return out.index_add_(0, seg, src)
def _pad(x, pw):
    flat = tuple(v for pair in reversed(pw) for v in pair)
    return torch.nn.functional.pad(x, flat)

kernel_name = 'concat_heads__mha_block__linear_kernel_hedgehog__prompt'

def setup_inputs():

    _w = (lambda a: (lambda t: t.to(torch.bfloat16) if t.is_floating_point() else t)(torch.as_tensor(a)))
    def _A_setup():
        B, S, D, H = 1, 2048, 448, 16
        return {
            "x": _w((lambda *s: torch.randn(*s, dtype=torch.bfloat16) * 0.4)(B, S, D)),
            "wqkv": _w((lambda *s: torch.randn(*s, dtype=torch.bfloat16) * 0.4)(D, 3 * D)),
            "wo": _w((lambda *s: torch.randn(*s, dtype=torch.bfloat16) * 0.05)(D, D)),
        }
    _A_in = _A_setup()

    def _B_setup():
        B, S, D, H = 1, 2048, 448, 16
        Dh = D // H
        return {
            "x": _w((lambda *s: torch.randn(*s, dtype=torch.bfloat16) * 0.8)(B, S, D)),
            "wqkv": _w((lambda *s: torch.randn(*s, dtype=torch.bfloat16) * 1.6)(D, 3 * D)),
            "w_phi": _w((lambda *s: torch.randn(*s, dtype=torch.bfloat16) * 1.6)(H, Dh, Dh) * (Dh ** -0.5)),
            "wo": _w((lambda *s: torch.randn(*s, dtype=torch.bfloat16) * 0.1)(D, D)),
        }
    _B_in = _B_setup()

    return {
        "A_x": _A_in["x"],
        "A_wqkv": _A_in["wqkv"],
        "A_wo": _A_in["wo"],
        "B_x": _B_in["x"],
        "B_wqkv": _B_in["wqkv"],
        "B_w_phi": _B_in["w_phi"],
        "B_wo": _B_in["wo"],
    }

def reference(A_x, A_wqkv, A_wo, B_x, B_wqkv, B_w_phi, B_wo):
    def _A_ref(x, wqkv, wo):
        B, S, D = x.shape
        H = 16
        Dh = D // H
        qkv = (lambda x, *d: x.permute(*d))((x @ wqkv).reshape(B, S, 3, H, Dh), 2, 0, 3, 1, 4)
        q, k, v = qkv[0], qkv[1], qkv[2]
        scores = torch.einsum("bhqd,bhkd->bhqk", q, k) * (Dh ** -0.5)
        p = _softmax(scores, axis=-1)
        o = torch.einsum("bhqk,bhkd->bhqd", p, v)
        return (lambda x, *d: x.permute(*d))(o, 0, 2, 1, 3).reshape(B, S, D) @ wo

    def _B_ref(x, wqkv, w_phi, wo):
        B, S, D = x.shape
        H = 16; Dh = D // H
        qkv = (lambda x, *d: x.permute(*d))((x @ wqkv).reshape(B, S, 3, H, Dh), 2, 0, 3, 1, 4)
        q, k, v = qkv[0], qkv[1], qkv[2]
        pq = torch.einsum("bhsd,hdf->bhsf", q, w_phi)
        pk = torch.einsum("bhsd,hdf->bhsf", k, w_phi)
        phi_q = torch.concatenate([_softmax(pq, axis=-1), _softmax(-pq, axis=-1)], axis=-1)
        phi_k = torch.concatenate([_softmax(pk, axis=-1), _softmax(-pk, axis=-1)], axis=-1)
        kv = torch.einsum("bhsf,bhsd->bhfd", phi_k, v)
        z  = torch.einsum("bhsf->bhf", phi_k)
        num = torch.einsum("bhqf,bhfd->bhqd", phi_q, kv)
        den = torch.einsum("bhqf,bhf->bhq", phi_q, z)[..., None] + 1e-6
        o = num / den
        return (lambda x, *d: x.permute(*d))(o, 0, 2, 1, 3).reshape(B, S, D) @ wo

    a = _A_ref(A_x, A_wqkv, A_wo)
    b = _B_ref(B_x, B_wqkv, B_w_phi, B_wo)
    return torch.concatenate([a, b], axis=-1)
```

```asm
; @launch kernel=qkv_kernel grid=(256,1,1) block=(512,1,1) lds=135168
; @launch kernel=attn_kernel grid=(256,1,1) block=(512,1,1) lds=22592
; @launch kernel=oproj_kernel grid=(224,1,1) block=(256,1,1) lds=77824
.amdgcn_target "amdgcn-amd-amdhsa--gfx950"
.text
.globl qkv_kernel
.p2align 12
.type qkv_kernel,@function
qkv_kernel:
    s_cmp_ge_u32 s2, 256
    s_cbranch_scc1 L1_end
    s_bfe_u32 s3, s2, 0x20003
    s_lshr_b32 s28, s2, 5
    s_and_b32 s28, s28, 4
    s_or_b32 s3, s3, s28
    s_cmp_ge_u32 s3, 3
    s_cselect_b32 s28, 24, 0
    s_load_dwordx4 s[4:7], s[0:1], s28
    s_load_dwordx2 s[8:9], s[0:1], 72
    s_load_dwordx2 s[10:11], s[0:1], 40
    v_lshrrev_b32 v2, 6, v0
    v_and_b32 v1, 63, v0
    v_readfirstlane_b32 s24, v2
    s_bfe_u32 s27, s2, 0x20001
    s_lshl_b32 s27, s27, 2
    s_bfe_u32 s25, s2, 0x20005
    s_add_u32 s27, s27, s25
    s_and_b32 s25, s2, 1
    v_lshlrev_b32 v2, 4, v1
    s_cmp_ge_u32 s3, 4
    s_cbranch_scc1 L1_kv
    s_lshl_b32 s26, s3, 1
    s_cmp_eq_u32 s3, 3
    s_cselect_b32 s26, 0, s26
    s_add_u32 s26, s26, s25
    s_cmp_lt_u32 s24, 4
    s_cbranch_scc1 L1_pc
    s_sub_u32 s24, s24, 4
    s_mul_i32 s32, s24, 43008
    s_mul_i32 s28, s26, 448
    s_add_u32 s32, s32, s28
    s_lshl_b32 s33, s27, 2
    s_add_u32 s33, s33, s24
    s_mul_i32 s33, s33, 28672
    s_mul_i32 s34, s24, 7168
    s_lshl_b32 s35, s24, 12
    s_add_u32 s35, s35, 28672
    s_add_u32 s31, s3, s27
    s_mul_i32 s28, s31, 64
    s_lshr_b32 s28, s28, 8
    s_mul_i32 s28, s28, 4
    s_sub_u32 s30, s31, s28
    s_mul_i32 s28, s31, 86
    s_lshr_b32 s28, s28, 8
    s_mul_i32 s28, s28, 3
    s_sub_u32 s47, s31, s28
    v_lshrrev_b32 v28, 3, v1
    v_mul_u32_u24 v28, 896, v28
    v_and_b32 v29, 7, v1
    v_lshrrev_b32 v30, 4, v1
    v_xor_b32 v29, v29, v30
    v_lshl_add_u32 v3, v29, 4, v28
    v_xor_b32 v29, 4, v29
    v_lshl_add_u32 v4, v29, 4, v28
    v_add_u32 v4, 7168, v4
    v_add_u32 v5, 14336, v3
    v_add_u32 v6, 14336, v4
    v_add_u32 v28, 0, v1
    v_mul_u32_u24 v29, 2341, v28
    v_lshrrev_b32 v29, 16, v29
    v_mul_u32_u24 v29, 2240, v29
    v_lshl_add_u32 v8, v28, 4, v29
    v_add_u32 v28, 64, v1
    v_mul_u32_u24 v29, 2341, v28
    v_lshrrev_b32 v29, 16, v29
    v_mul_u32_u24 v29, 2240, v29
    v_lshl_add_u32 v9, v28, 4, v29
    s_mov_b32 s14, 0x126000
    s_mov_b32 s15, 0x00020000
    s_mov_b32 s58, 0x1c0000
    s_mov_b32 s59, 0x00020000
    s_add_u32 s31, s30, 0
    s_sub_u32 s28, s31, 4
    s_cmp_ge_u32 s31, 4
    s_cselect_b32 s31, s28, s31
    s_lshl_b32 s29, s31, 7
    s_add_u32 s29, s29, s33
    s_mul_i32 s36, s31, 172032
    s_add_u32 s36, s36, s32
    s_waitcnt lgkmcnt(0)
    s_mov_b32 s56, s4
    s_mov_b32 s57, s5
    s_mov_b32 s12, s6
    s_mov_b32 s13, s7
    s_add_u32 m0, s35, 0
    s_nop 0
    buffer_load_dwordx4 v3, s[56:59], s29 offen lds
    s_add_u32 m0, s35, 1024
    s_nop 0
    buffer_load_dwordx4 v4, s[56:59], s29 offen lds
    s_add_u32 m0, s35, 2048
    s_nop 0
    buffer_load_dwordx4 v5, s[56:59], s29 offen lds
    s_add_u32 m0, s35, 3072
    s_nop 0
    buffer_load_dwordx4 v6, s[56:59], s29 offen lds
    s_add_u32 m0, s34, 0
    s_nop 0
    buffer_load_dwordx4 v8, s[12:15], s36 offen lds
    s_add_u32 m0, s34, 1024
    s_nop 0
    buffer_load_dwordx4 v9, s[12:15], s36 offen lds
    v_add_u32 v28, 128, v1
    v_mul_u32_u24 v29, 2341, v28
    v_lshrrev_b32 v29, 16, v29
    v_mul_u32_u24 v29, 2240, v29
    v_lshl_add_u32 v10, v28, 4, v29
    s_add_u32 m0, s34, 2048
    s_nop 0
    buffer_load_dwordx4 v10, s[12:15], s36 offen lds
    v_add_u32 v28, 192, v1
    v_mul_u32_u24 v29, 2341, v28
    v_lshrrev_b32 v29, 16, v29
    v_mul_u32_u24 v29, 2240, v29
    v_lshl_add_u32 v11, v28, 4, v29
    s_add_u32 m0, s34, 3072
    s_nop 0
    buffer_load_dwordx4 v11, s[12:15], s36 offen lds
    v_add_u32 v28, 256, v1
    v_mul_u32_u24 v29, 2341, v28
    v_lshrrev_b32 v29, 16, v29
    v_mul_u32_u24 v29, 2240, v29
    v_lshl_add_u32 v12, v28, 4, v29
    s_add_u32 m0, s34, 4096
    s_nop 0
    buffer_load_dwordx4 v12, s[12:15], s36 offen lds
    v_add_u32 v28, 320, v1
    v_mul_u32_u24 v29, 2341, v28
    v_lshrrev_b32 v29, 16, v29
    v_mul_u32_u24 v29, 2240, v29
    v_lshl_add_u32 v13, v28, 4, v29
    s_add_u32 m0, s34, 5120
    s_nop 0
    buffer_load_dwordx4 v13, s[12:15], s36 offen lds
    v_add_u32 v28, 384, v1
    v_mul_u32_u24 v29, 2341, v28
    v_lshrrev_b32 v29, 16, v29
    v_mul_u32_u24 v29, 2240, v29
    v_lshl_add_u32 v14, v28, 4, v29
    s_add_u32 m0, s34, 6144
    s_nop 0
    buffer_load_dwordx4 v14, s[12:15], s36 offen lds
    s_add_u32 s31, s30, 1
    s_sub_u32 s28, s31, 4
    s_cmp_ge_u32 s31, 4
    s_cselect_b32 s31, s28, s31
    s_lshl_b32 s29, s31, 7
    s_add_u32 s29, s29, s33
    s_mul_i32 s36, s31, 172032
    s_add_u32 s36, s36, s32
    s_add_u32 m0, s35, 45056
    s_nop 0
    buffer_load_dwordx4 v3, s[56:59], s29 offen lds
    s_add_u32 m0, s35, 46080
    s_nop 0
    buffer_load_dwordx4 v4, s[56:59], s29 offen lds
    s_add_u32 m0, s35, 47104
    s_nop 0
    buffer_load_dwordx4 v5, s[56:59], s29 offen lds
    s_add_u32 m0, s35, 48128
    s_nop 0
    buffer_load_dwordx4 v6, s[56:59], s29 offen lds
    s_add_u32 m0, s34, 45056
    s_nop 0
    buffer_load_dwordx4 v8, s[12:15], s36 offen lds
    s_add_u32 m0, s34, 46080
    s_nop 0
    buffer_load_dwordx4 v9, s[12:15], s36 offen lds
    s_add_u32 m0, s34, 47104
    s_nop 0
    buffer_load_dwordx4 v10, s[12:15], s36 offen lds
    s_add_u32 m0, s34, 48128
    s_nop 0
    buffer_load_dwordx4 v11, s[12:15], s36 offen lds
    s_add_u32 m0, s34, 49152
    s_nop 0
    buffer_load_dwordx4 v12, s[12:15], s36 offen lds
    s_add_u32 m0, s34, 50176
    s_nop 0
    buffer_load_dwordx4 v13, s[12:15], s36 offen lds
    s_add_u32 m0, s34, 51200
    s_nop 0
    buffer_load_dwordx4 v14, s[12:15], s36 offen lds
    s_waitcnt vmcnt(11)
    s_barrier
    s_add_u32 s31, s30, 2
    s_sub_u32 s28, s31, 4
    s_cmp_ge_u32 s31, 4
    s_cselect_b32 s31, s28, s31
    s_lshl_b32 s29, s31, 7
    s_add_u32 s29, s29, s33
    s_mul_i32 s36, s31, 172032
    s_add_u32 s36, s36, s32
    s_add_u32 m0, s35, 90112
    s_nop 0
    buffer_load_dwordx4 v3, s[56:59], s29 offen lds
    s_add_u32 m0, s35, 91136
    s_nop 0
    buffer_load_dwordx4 v4, s[56:59], s29 offen lds
    s_add_u32 m0, s35, 92160
    s_nop 0
    buffer_load_dwordx4 v5, s[56:59], s29 offen lds
    s_add_u32 m0, s35, 93184
    s_nop 0
    buffer_load_dwordx4 v6, s[56:59], s29 offen lds
    s_add_u32 m0, s34, 90112
    s_nop 0
    buffer_load_dwordx4 v8, s[12:15], s36 offen lds
    s_add_u32 m0, s34, 91136
    s_nop 0
    buffer_load_dwordx4 v9, s[12:15], s36 offen lds
    s_add_u32 m0, s34, 92160
    s_nop 0
    buffer_load_dwordx4 v10, s[12:15], s36 offen lds
    s_add_u32 m0, s34, 93184
    s_nop 0
    buffer_load_dwordx4 v11, s[12:15], s36 offen lds
    s_add_u32 m0, s34, 94208
    s_nop 0
    buffer_load_dwordx4 v12, s[12:15], s36 offen lds
    s_add_u32 m0, s34, 95232
    s_nop 0
    buffer_load_dwordx4 v13, s[12:15], s36 offen lds
    s_add_u32 m0, s34, 96256
    s_nop 0
    buffer_load_dwordx4 v14, s[12:15], s36 offen lds
    s_waitcnt vmcnt(11)
    s_barrier
    s_add_u32 s31, s30, 3
    s_sub_u32 s28, s31, 4
    s_cmp_ge_u32 s31, 4
    s_cselect_b32 s31, s28, s31
    s_lshl_b32 s29, s31, 7
    s_add_u32 s29, s29, s33
    s_mul_i32 s36, s31, 172032
    s_add_u32 s36, s36, s32
    s_add_u32 m0, s35, 0
    s_nop 0
    buffer_load_dwordx4 v3, s[56:59], s29 offen lds
    s_add_u32 m0, s35, 1024
    s_nop 0
    buffer_load_dwordx4 v4, s[56:59], s29 offen lds
    s_add_u32 m0, s35, 2048
    s_nop 0
    buffer_load_dwordx4 v5, s[56:59], s29 offen lds
    s_add_u32 m0, s35, 3072
    s_nop 0
    buffer_load_dwordx4 v6, s[56:59], s29 offen lds
    s_add_u32 m0, s34, 0
    s_nop 0
    buffer_load_dwordx4 v8, s[12:15], s36 offen lds
    s_add_u32 m0, s34, 1024
    s_nop 0
    buffer_load_dwordx4 v9, s[12:15], s36 offen lds
    s_add_u32 m0, s34, 2048
    s_nop 0
    buffer_load_dwordx4 v10, s[12:15], s36 offen lds
    s_add_u32 m0, s34, 3072
    s_nop 0
    buffer_load_dwordx4 v11, s[12:15], s36 offen lds
    s_add_u32 m0, s34, 4096
    s_nop 0
    buffer_load_dwordx4 v12, s[12:15], s36 offen lds
    s_add_u32 m0, s34, 5120
    s_nop 0
    buffer_load_dwordx4 v13, s[12:15], s36 offen lds
    s_add_u32 m0, s34, 6144
    s_nop 0
    buffer_load_dwordx4 v14, s[12:15], s36 offen lds
    s_waitcnt vmcnt(11)
    s_barrier
    s_add_u32 s31, s47, 4
    s_sub_u32 s28, s31, 3
    s_cmp_ge_u32 s31, 7
    s_cselect_b32 s31, s28, s31
    s_lshl_b32 s29, s31, 7
    s_add_u32 s29, s29, s33
    s_mul_i32 s36, s31, 172032
    s_add_u32 s36, s36, s32
    s_add_u32 m0, s35, 45056
    s_nop 0
    buffer_load_dwordx4 v3, s[56:59], s29 offen lds
    s_add_u32 m0, s35, 46080
    s_nop 0
    buffer_load_dwordx4 v4, s[56:59], s29 offen lds
    s_add_u32 m0, s35, 47104
    s_nop 0
    buffer_load_dwordx4 v5, s[56:59], s29 offen lds
    s_add_u32 m0, s35, 48128
    s_nop 0
    buffer_load_dwordx4 v6, s[56:59], s29 offen lds
    s_add_u32 m0, s34, 45056
    s_nop 0
    buffer_load_dwordx4 v8, s[12:15], s36 offen lds
    s_add_u32 m0, s34, 46080
    s_nop 0
    buffer_load_dwordx4 v9, s[12:15], s36 offen lds
    s_add_u32 m0, s34, 47104
    s_nop 0
    buffer_load_dwordx4 v10, s[12:15], s36 offen lds
    s_add_u32 m0, s34, 48128
    s_nop 0
    buffer_load_dwordx4 v11, s[12:15], s36 offen lds
    s_add_u32 m0, s34, 49152
    s_nop 0
    buffer_load_dwordx4 v12, s[12:15], s36 offen lds
    s_add_u32 m0, s34, 50176
    s_nop 0
    buffer_load_dwordx4 v13, s[12:15], s36 offen lds
    s_add_u32 m0, s34, 51200
    s_nop 0
    buffer_load_dwordx4 v14, s[12:15], s36 offen lds
    s_waitcnt vmcnt(11)
    s_barrier
    s_add_u32 s31, s47, 5
    s_sub_u32 s28, s31, 3
    s_cmp_ge_u32 s31, 7
    s_cselect_b32 s31, s28, s31
    s_lshl_b32 s29, s31, 7
    s_add_u32 s29, s29, s33
    s_mul_i32 s36, s31, 172032
    s_add_u32 s36, s36, s32
    s_add_u32 m0, s35, 90112
    s_nop 0
    buffer_load_dwordx4 v3, s[56:59], s29 offen lds
    s_add_u32 m0, s35, 91136
    s_nop 0
    buffer_load_dwordx4 v4, s[56:59], s29 offen lds
    s_add_u32 m0, s35, 92160
    s_nop 0
    buffer_load_dwordx4 v5, s[56:59], s29 offen lds
    s_add_u32 m0, s35, 93184
    s_nop 0
    buffer_load_dwordx4 v6, s[56:59], s29 offen lds
    s_add_u32 m0, s34, 90112
    s_nop 0
    buffer_load_dwordx4 v8, s[12:15], s36 offen lds
    s_add_u32 m0, s34, 91136
    s_nop 0
    buffer_load_dwordx4 v9, s[12:15], s36 offen lds
    s_add_u32 m0, s34, 92160
    s_nop 0
    buffer_load_dwordx4 v10, s[12:15], s36 offen lds
    s_add_u32 m0, s34, 93184
    s_nop 0
    buffer_load_dwordx4 v11, s[12:15], s36 offen lds
    s_add_u32 m0, s34, 94208
    s_nop 0
    buffer_load_dwordx4 v12, s[12:15], s36 offen lds
    s_add_u32 m0, s34, 95232
    s_nop 0
    buffer_load_dwordx4 v13, s[12:15], s36 offen lds
    s_add_u32 m0, s34, 96256
    s_nop 0
    buffer_load_dwordx4 v14, s[12:15], s36 offen lds
    s_waitcnt vmcnt(11)
    s_barrier
    s_add_u32 s31, s47, 6
    s_sub_u32 s28, s31, 3
    s_cmp_ge_u32 s31, 7
    s_cselect_b32 s31, s28, s31
    s_lshl_b32 s29, s31, 7
    s_add_u32 s29, s29, s33
    s_mul_i32 s36, s31, 172032
    s_add_u32 s36, s36, s32
    s_add_u32 m0, s35, 0
    s_nop 0
    buffer_load_dwordx4 v3, s[56:59], s29 offen lds
    s_add_u32 m0, s35, 1024
    s_nop 0
    buffer_load_dwordx4 v4, s[56:59], s29 offen lds
    s_add_u32 m0, s35, 2048
    s_nop 0
    buffer_load_dwordx4 v5, s[56:59], s29 offen lds
    s_add_u32 m0, s35, 3072
    s_nop 0
    buffer_load_dwordx4 v6, s[56:59], s29 offen lds
    s_add_u32 m0, s34, 0
    s_nop 0
    buffer_load_dwordx4 v8, s[12:15], s36 offen lds
    s_add_u32 m0, s34, 1024
    s_nop 0
    buffer_load_dwordx4 v9, s[12:15], s36 offen lds
    s_add_u32 m0, s34, 2048
    s_nop 0
    buffer_load_dwordx4 v10, s[12:15], s36 offen lds
    s_add_u32 m0, s34, 3072
    s_nop 0
    buffer_load_dwordx4 v11, s[12:15], s36 offen lds
    s_add_u32 m0, s34, 4096
    s_nop 0
    buffer_load_dwordx4 v12, s[12:15], s36 offen lds
    s_add_u32 m0, s34, 5120
    s_nop 0
    buffer_load_dwordx4 v13, s[12:15], s36 offen lds
    s_add_u32 m0, s34, 6144
    s_nop 0
    buffer_load_dwordx4 v14, s[12:15], s36 offen lds
    s_waitcnt vmcnt(11)
    s_barrier
    s_waitcnt vmcnt(0)
    s_barrier
    s_endpgm
L1_kv:
    s_lshl_b32 s26, s25, 2
    s_and_b32 s28, s3, 3
    s_add_u32 s26, s26, s28
    s_cmp_lt_u32 s24, 4
    s_cbranch_scc1 L1_kx
    s_lshl_b32 s28, s24, 8
    s_sub_u32 s28, s28, 1024
    v_add_u32 v32, s28, v1
    v_mov_b32 v33, 0x40000000
    v_add_u32 v28, 0, v32
    v_mul_u32_u24 v29, 9363, v28
    v_lshrrev_b32 v29, 16, v29
    v_lshlrev_b32 v3, 4, v28
    v_mul_u32_u24 v30, 784, v29
    v_add_u32 v3, v3, v30
    v_lshrrev_b32 v29, 1, v29
    v_mul_u32_u24 v29, 896, v29
    v_add_u32 v3, v3, v29
    v_cmp_gt_u32 vcc, 896, v28
    s_nop 1
    v_cndmask_b32 v3, v33, v3, vcc
    v_add_u32 v28, 64, v32
    v_mul_u32_u24 v29, 9363, v28
    v_lshrrev_b32 v29, 16, v29
    v_lshlrev_b32 v4, 4, v28
    v_mul_u32_u24 v30, 784, v29
    v_add_u32 v4, v4, v30
    v_lshrrev_b32 v29, 1, v29
    v_mul_u32_u24 v29, 896, v29
    v_add_u32 v4, v4, v29
    v_cmp_gt_u32 vcc, 896, v28
    s_nop 1
    v_cndmask_b32 v4, v33, v4, vcc
    v_add_u32 v28, 128, v32
    v_mul_u32_u24 v29, 9363, v28
    v_lshrrev_b32 v29, 16, v29
    v_lshlrev_b32 v5, 4, v28
    v_mul_u32_u24 v30, 784, v29
    v_add_u32 v5, v5, v30
    v_lshrrev_b32 v29, 1, v29
    v_mul_u32_u24 v29, 896, v29
    v_add_u32 v5, v5, v29
    v_cmp_gt_u32 vcc, 896, v28
    s_nop 1
    v_cndmask_b32 v5, v33, v5, vcc
    v_add_u32 v28, 192, v32
    v_mul_u32_u24 v29, 9363, v28
    v_lshrrev_b32 v29, 16, v29
    v_lshlrev_b32 v6, 4, v28
    v_mul_u32_u24 v30, 784, v29
    v_add_u32 v6, v6, v30
    v_lshrrev_b32 v29, 1, v29
    v_mul_u32_u24 v29, 896, v29
    v_add_u32 v6, v6, v29
    v_cmp_gt_u32 vcc, 896, v28
    s_nop 1
    v_cndmask_b32 v6, v33, v6, vcc
    s_mul_i32 s32, s26, 112
    s_add_u32 s32, s32, 896
    s_mov_b32 s33, 172032
    s_lshl_b32 s34, s24, 12
    s_sub_u32 s34, s34, 16384
    s_waitcnt lgkmcnt(0)
    s_mov_b32 s12, s6
    s_mov_b32 s13, s7
    s_mov_b32 s14, 0x126000
    s_mov_b32 s15, 0x00020000
    s_branch L1_kgo
L1_kx:
    v_lshrrev_b32 v28, 3, v1
    v_mul_u32_u24 v28, 896, v28
    v_and_b32 v29, 7, v1
    v_lshrrev_b32 v30, 4, v1
    v_xor_b32 v29, v29, v30
    v_lshl_add_u32 v3, v29, 4, v28
    v_xor_b32 v29, 4, v29
    v_lshl_add_u32 v4, v29, 4, v28
    v_add_u32 v4, 7168, v4
    v_add_u32 v5, 14336, v3
    v_add_u32 v6, 14336, v4
    s_lshl_b32 s32, s27, 2
    s_add_u32 s32, s32, s24
    s_mul_i32 s32, s32, 28672
    s_mov_b32 s33, 128
    s_lshl_b32 s34, s24, 12
    s_add_u32 m0, s34, 0
    s_add_u32 s34, s34, 16384
    s_lshl_b32 s29, s24, 10
    s_mul_i32 s28, s26, 3136
    s_add_u32 s28, s28, s29
    s_add_u32 m0, s29, 131072
    s_waitcnt lgkmcnt(0)
    s_mov_b32 s20, s10
    s_mov_b32 s21, s11
    s_mov_b32 s22, 0x6200
    s_mov_b32 s23, 0x00020000
    s_mov_b32 s12, s4
    s_mov_b32 s13, s5
    s_mov_b32 s14, 0x1c0000
    s_mov_b32 s15, 0x00020000
    buffer_load_dwordx4 v2, s[20:23], s28 offen lds
L1_kgo:
    s_add_u32 s31, s3, s27
    s_mul_i32 s28, s31, 64
    s_lshr_b32 s28, s28, 8
    s_mul_i32 s28, s28, 4
    s_sub_u32 s30, s31, s28
    s_mul_i32 s28, s31, 86
    s_lshr_b32 s28, s28, 8
    s_mul_i32 s28, s28, 3
    s_sub_u32 s47, s31, s28
    s_add_u32 s31, s30, 0
    s_sub_u32 s28, s31, 4
    s_cmp_ge_u32 s31, 4
    s_cselect_b32 s31, s28, s31
    s_mul_i32 s36, s31, s33
    s_add_u32 s36, s36, s32
    s_add_u32 m0, s34, 0
    s_nop 0
    buffer_load_dwordx4 v3, s[12:15], s36 offen lds
    s_add_u32 m0, s34, 1024
    s_nop 0
    buffer_load_dwordx4 v4, s[12:15], s36 offen lds
    s_add_u32 m0, s34, 2048
    s_nop 0
    buffer_load_dwordx4 v5, s[12:15], s36 offen lds
    s_add_u32 m0, s34, 3072
    s_nop 0
    buffer_load_dwordx4 v6, s[12:15], s36 offen lds
    s_barrier
    s_add_u32 s31, s30, 1
    s_sub_u32 s28, s31, 4
    s_cmp_ge_u32 s31, 4
    s_cselect_b32 s31, s28, s31
    s_mul_i32 s36, s31, s33
    s_add_u32 s36, s36, s32
    s_add_u32 m0, s34, 32768
    s_nop 0
    buffer_load_dwordx4 v3, s[12:15], s36 offen lds
    s_add_u32 m0, s34, 33792
    s_nop 0
    buffer_load_dwordx4 v4, s[12:15], s36 offen lds
    s_add_u32 m0, s34, 34816
    s_nop 0
    buffer_load_dwordx4 v5, s[12:15], s36 offen lds
    s_add_u32 m0, s34, 35840
    s_nop 0
    buffer_load_dwordx4 v6, s[12:15], s36 offen lds
    s_branch L1_kset
.p2align 12
L1_pc:
    s_getpc_b64 s[48:49]
Lcp1:
    s_add_u32 s48, s48, Lcp1-Lcp1
    s_addc_u32 s49, s49, 0
    s_mov_b32 s50, L_code_end-Lcp1
    s_mov_b32 s51, 0x00020000
    v_mul_u32_u24 v27, 512, v1
    s_lshl_b32 s52, s24, 7
    buffer_load_dword v27, v27, s[48:51], s52 offen
    s_and_b32 s29, s24, 1
    s_lshl_b32 s29, s29, 13
    s_add_u32 s29, s29, 28672
    s_lshr_b32 s28, s24, 1
    s_mul_i32 s28, s28, 224
    v_and_b32 v28, 31, v1
    v_lshrrev_b32 v29, 5, v1
    v_bfe_u32 v30, v1, 1, 3
    v_xor_b32 v30, v30, v29
    v_lshlrev_b32 v31, 7, v28
    v_add_u32 v31, s29, v31
    v_lshl_add_u32 v10, v30, 4, v31
    v_xor_b32 v32, 2, v30
    v_lshl_add_u32 v11, v32, 4, v31
    v_xor_b32 v32, 4, v30
    v_lshl_add_u32 v12, v32, 4, v31
    v_xor_b32 v32, 6, v30
    v_lshl_add_u32 v13, v32, 4, v31
    v_bfe_u32 v30, v1, 4, 1
    v_lshlrev_b32 v31, 5, v30
    v_and_b32 v30, 3, v1
    v_lshl_add_u32 v31, v30, 3, v31
    v_bfe_u32 v30, v1, 2, 2
    v_lshl_add_u32 v32, v29, 3, v30
    v_mul_u32_u24 v32, 448, v32
    v_add3_u32 v22, v32, v31, s28
    v_mov_b32 v33, 0x3f803f80
    v_cmp_eq_u32 vcc, 28, v28
    s_nop 1
    v_cndmask_b32 v25, 0, v33, vcc
    v_mov_b32 v164, 0
    v_mov_b32 v165, 0
    v_mov_b32 v166, 0
    v_mov_b32 v167, 0
    s_and_b32 s40, s26, 1
    s_lshl_b32 s40, s40, 3
    s_and_b32 s28, s24, 2
    s_lshl_b32 s28, s28, 1
    s_add_u32 s40, s40, s28
    s_lshl_b32 s41, s40, 6
    s_lshl_b32 s28, s27, 2
    s_add_u32 s41, s41, s28
    s_and_b32 s28, s24, 1
    s_lshl_b32 s28, s28, 1
    s_add_u32 s41, s41, s28
    s_mov_b32 s42, 0x3e8b97f6
    s_mov_b32 s43, 0x3e8b97f6
    s_mov_b32 s31, 7
    s_mov_b32 s36, 0
    s_lshr_b32 s28, s26, 1
    s_cmp_eq_u32 s28, 1
    s_cselect_b32 s44, 0x3f803f80, 0
    s_cselect_b32 s45, 0x3f80, 0
    s_cselect_b32 s46, 12, 11
    s_cselect_b32 s29, 0, 4194304
    s_cmp_eq_u32 s3, 3
    s_cselect_b32 s29, 6291456, s29
    s_waitcnt lgkmcnt(0)
    v_mfma_f32_32x32x16_bf16 v[36:51], v[164:167], v[164:167], 0
    v_mfma_f32_32x32x16_bf16 v[52:67], v[164:167], v[164:167], 0
    v_mfma_f32_32x32x16_bf16 v[68:83], v[164:167], v[164:167], 0
    v_mfma_f32_32x32x16_bf16 v[84:99], v[164:167], v[164:167], 0
    v_mfma_f32_32x32x16_bf16 v[100:115], v[164:167], v[164:167], 0
    v_mfma_f32_32x32x16_bf16 v[116:131], v[164:167], v[164:167], 0
    v_mfma_f32_32x32x16_bf16 v[132:147], v[164:167], v[164:167], 0
    v_mfma_f32_32x32x16_bf16 v[148:163], v[164:167], v[164:167], 0
    s_mov_b32 s16, s8
    s_mov_b32 s17, s9
    s_mov_b32 s18, 0xf00000
    s_mov_b32 s19, 0x00020000
    s_cmp_eq_u32 s3, 2
    s_cbranch_scc1 L1_pv
    s_barrier
    ds_read_b128 v[164:167], v10 offset:0
    ds_read_b128 v[168:171], v10 offset:4096
    ds_read_b64_tr_b16 v[172:173], v22 offset:0
    ds_read_b64_tr_b16 v[174:175], v22 offset:1792
    ds_read_b64_tr_b16 v[176:177], v22 offset:56
    ds_read_b64_tr_b16 v[178:179], v22 offset:1848
    ds_read_b64_tr_b16 v[180:181], v22 offset:112
    ds_read_b64_tr_b16 v[182:183], v22 offset:1904
    ds_read_b64_tr_b16 v[184:185], v22 offset:168
    ds_read_b64_tr_b16 v[186:187], v22 offset:1960
L1_ploop:
    s_waitcnt lgkmcnt(0)
    v_mfma_f32_32x32x16_bf16 v[36:51], v[172:175], v[164:167], v[36:51]
    ds_read_b128 v[188:191], v11 offset:0
    ds_read_b128 v[192:195], v11 offset:4096
    v_mfma_f32_32x32x16_bf16 v[52:67], v[172:175], v[168:171], v[52:67]
    ds_read_b64_tr_b16 v[196:197], v22 offset:7168
    ds_read_b64_tr_b16 v[198:199], v22 offset:8960
    v_mfma_f32_32x32x16_bf16 v[68:83], v[176:179], v[164:167], v[68:83]
    ds_read_b64_tr_b16 v[200:201], v22 offset:7224
    ds_read_b64_tr_b16 v[202:203], v22 offset:9016
    v_mfma_f32_32x32x16_bf16 v[84:99], v[176:179], v[168:171], v[84:99]
    ds_read_b64_tr_b16 v[204:205], v22 offset:7280
    ds_read_b64_tr_b16 v[206:207], v22 offset:9072
    v_mfma_f32_32x32x16_bf16 v[100:115], v[180:183], v[164:167], v[100:115]
    ds_read_b64_tr_b16 v[208:209], v22 offset:7336
    ds_read_b64_tr_b16 v[210:211], v22 offset:9128
    v_mfma_f32_32x32x16_bf16 v[116:131], v[180:183], v[168:171], v[116:131]
    s_add_u32 s36, s36, 1
    s_cmp_eq_u32 s36, 3
    v_mfma_f32_32x32x16_bf16 v[132:147], v[184:187], v[164:167], v[132:147]
    s_cselect_b32 s36, 0, s36
    s_cselect_b32 s33, 4294877184, 0
    v_mfma_f32_32x32x16_bf16 v[148:163], v[184:187], v[168:171], v[148:163]
    s_cselect_b32 s33, s33, 45056
    s_waitcnt lgkmcnt(0)
    v_mfma_f32_32x32x16_bf16 v[36:51], v[196:199], v[188:191], v[36:51]
    ds_read_b128 v[164:167], v12 offset:0
    ds_read_b128 v[168:171], v12 offset:4096
    v_mfma_f32_32x32x16_bf16 v[52:67], v[196:199], v[192:195], v[52:67]
    ds_read_b64_tr_b16 v[172:173], v22 offset:14336
    ds_read_b64_tr_b16 v[174:175], v22 offset:16128
    v_mfma_f32_32x32x16_bf16 v[68:83], v[200:203], v[188:191], v[68:83]
    ds_read_b64_tr_b16 v[176:177], v22 offset:14392
    ds_read_b64_tr_b16 v[178:179], v22 offset:16184
    v_mfma_f32_32x32x16_bf16 v[84:99], v[200:203], v[192:195], v[84:99]
    ds_read_b64_tr_b16 v[180:181], v22 offset:14448
    ds_read_b64_tr_b16 v[182:183], v22 offset:16240
    v_mfma_f32_32x32x16_bf16 v[100:115], v[204:207], v[188:191], v[100:115]
    ds_read_b64_tr_b16 v[184:185], v22 offset:14504
    ds_read_b64_tr_b16 v[186:187], v22 offset:16296
    v_mfma_f32_32x32x16_bf16 v[116:131], v[204:207], v[192:195], v[116:131]
    v_mfma_f32_32x32x16_bf16 v[132:147], v[208:211], v[188:191], v[132:147]
    v_mfma_f32_32x32x16_bf16 v[148:163], v[208:211], v[192:195], v[148:163]
    s_waitcnt lgkmcnt(0)
    v_mfma_f32_32x32x16_bf16 v[36:51], v[172:175], v[164:167], v[36:51]
    ds_read_b128 v[188:191], v13 offset:0
    ds_read_b128 v[192:195], v13 offset:4096
    v_mfma_f32_32x32x16_bf16 v[52:67], v[172:175], v[168:171], v[52:67]
    ds_read_b64_tr_b16 v[196:197], v22 offset:21504
    ds_read_b64_tr_b16 v[198:199], v22 offset:23296
    v_mfma_f32_32x32x16_bf16 v[68:83], v[176:179], v[164:167], v[68:83]
    ds_read_b64_tr_b16 v[200:201], v22 offset:21560
    ds_read_b64_tr_b16 v[202:203], v22 offset:23352
    v_mfma_f32_32x32x16_bf16 v[84:99], v[176:179], v[168:171], v[84:99]
    ds_read_b64_tr_b16 v[204:205], v22 offset:21616
    ds_read_b64_tr_b16 v[206:207], v22 offset:23408
    v_mfma_f32_32x32x16_bf16 v[100:115], v[180:183], v[164:167], v[100:115]
    ds_read_b64_tr_b16 v[208:209], v22 offset:21672
    ds_read_b64_tr_b16 v[210:211], v22 offset:23464
    v_mfma_f32_32x32x16_bf16 v[116:131], v[180:183], v[168:171], v[116:131]
    v_mfma_f32_32x32x16_bf16 v[132:147], v[184:187], v[164:167], v[132:147]
    v_mfma_f32_32x32x16_bf16 v[148:163], v[184:187], v[168:171], v[148:163]
    s_waitcnt lgkmcnt(0)
    s_barrier
    v_add_u32 v10, s33, v10
    v_add_u32 v11, s33, v11
    v_add_u32 v12, s33, v12
    v_add_u32 v13, s33, v13
    v_add_u32 v22, s33, v22
    v_mfma_f32_32x32x16_bf16 v[36:51], v[196:199], v[188:191], v[36:51]
    ds_read_b128 v[164:167], v10 offset:0
    ds_read_b128 v[168:171], v10 offset:4096
    v_mfma_f32_32x32x16_bf16 v[52:67], v[196:199], v[192:195], v[52:67]
    ds_read_b64_tr_b16 v[172:173], v22 offset:0
    ds_read_b64_tr_b16 v[174:175], v22 offset:1792
    v_mfma_f32_32x32x16_bf16 v[68:83], v[200:203], v[188:191], v[68:83]
    ds_read_b64_tr_b16 v[176:177], v22 offset:56
    ds_read_b64_tr_b16 v[178:179], v22 offset:1848
    v_mfma_f32_32x32x16_bf16 v[84:99], v[200:203], v[192:195], v[84:99]
    ds_read_b64_tr_b16 v[180:181], v22 offset:112
    ds_read_b64_tr_b16 v[182:183], v22 offset:1904
    v_mfma_f32_32x32x16_bf16 v[100:115], v[204:207], v[188:191], v[100:115]
    ds_read_b64_tr_b16 v[184:185], v22 offset:168
    ds_read_b64_tr_b16 v[186:187], v22 offset:1960
    v_mfma_f32_32x32x16_bf16 v[116:131], v[204:207], v[192:195], v[116:131]
    v_mfma_f32_32x32x16_bf16 v[132:147], v[208:211], v[188:191], v[132:147]
    s_sub_u32 s31, s31, 1
    s_cmp_lg_u32 s31, 0
    v_mfma_f32_32x32x16_bf16 v[148:163], v[208:211], v[192:195], v[148:163]
    s_cbranch_scc1 L1_ploop
    s_cmp_lg_u32 s3, 0
    s_cbranch_scc1 L1_pnoscale
    v_pk_mul_f32 v[36:37], v[36:37], s[42:43]
    v_pk_mul_f32 v[38:39], v[38:39], s[42:43]
    v_pk_mul_f32 v[40:41], v[40:41], s[42:43]
    v_pk_mul_f32 v[42:43], v[42:43], s[42:43]
    v_pk_mul_f32 v[44:45], v[44:45], s[42:43]
    v_pk_mul_f32 v[46:47], v[46:47], s[42:43]
    v_pk_mul_f32 v[48:49], v[48:49], s[42:43]
    v_pk_mul_f32 v[50:51], v[50:51], s[42:43]
    v_pk_mul_f32 v[52:53], v[52:53], s[42:43]
    v_pk_mul_f32 v[54:55], v[54:55], s[42:43]
    v_pk_mul_f32 v[56:57], v[56:57], s[42:43]
    v_pk_mul_f32 v[58:59], v[58:59], s[42:43]
    v_pk_mul_f32 v[60:61], v[60:61], s[42:43]
    v_pk_mul_f32 v[62:63], v[62:63], s[42:43]
    v_pk_mul_f32 v[64:65], v[64:65], s[42:43]
    v_pk_mul_f32 v[66:67], v[66:67], s[42:43]
    v_pk_mul_f32 v[68:69], v[68:69], s[42:43]
    v_pk_mul_f32 v[70:71], v[70:71], s[42:43]
    v_pk_mul_f32 v[72:73], v[72:73], s[42:43]
    v_pk_mul_f32 v[74:75], v[74:75], s[42:43]
    v_pk_mul_f32 v[76:77], v[76:77], s[42:43]
    v_pk_mul_f32 v[78:79], v[78:79], s[42:43]
    v_pk_mul_f32 v[80:81], v[80:81], s[42:43]
    v_pk_mul_f32 v[82:83], v[82:83], s[42:43]
    v_pk_mul_f32 v[84:85], v[84:85], s[42:43]
    v_pk_mul_f32 v[86:87], v[86:87], s[42:43]
    v_pk_mul_f32 v[88:89], v[88:89], s[42:43]
    v_pk_mul_f32 v[90:91], v[90:91], s[42:43]
    v_pk_mul_f32 v[92:93], v[92:93], s[42:43]
    v_pk_mul_f32 v[94:95], v[94:95], s[42:43]
    v_pk_mul_f32 v[96:97], v[96:97], s[42:43]
    v_pk_mul_f32 v[98:99], v[98:99], s[42:43]
    v_pk_mul_f32 v[100:101], v[100:101], s[42:43]
    v_pk_mul_f32 v[102:103], v[102:103], s[42:43]
    v_pk_mul_f32 v[104:105], v[104:105], s[42:43]
    v_pk_mul_f32 v[106:107], v[106:107], s[42:43]
    v_pk_mul_f32 v[108:109], v[108:109], s[42:43]
    v_pk_mul_f32 v[110:111], v[110:111], s[42:43]
    v_pk_mul_f32 v[112:113], v[112:113], s[42:43]
    v_pk_mul_f32 v[114:115], v[114:115], s[42:43]
    v_pk_mul_f32 v[116:117], v[116:117], s[42:43]
    v_pk_mul_f32 v[118:119], v[118:119], s[42:43]
    v_pk_mul_f32 v[120:121], v[120:121], s[42:43]
    v_pk_mul_f32 v[122:123], v[122:123], s[42:43]
    v_pk_mul_f32 v[124:125], v[124:125], s[42:43]
    v_pk_mul_f32 v[126:127], v[126:127], s[42:43]
    v_pk_mul_f32 v[128:129], v[128:129], s[42:43]
    v_pk_mul_f32 v[130:131], v[130:131], s[42:43]
    v_pk_mul_f32 v[132:133], v[132:133], s[42:43]
    v_pk_mul_f32 v[134:135], v[134:135], s[42:43]
    v_pk_mul_f32 v[136:137], v[136:137], s[42:43]
    v_pk_mul_f32 v[138:139], v[138:139], s[42:43]
    v_pk_mul_f32 v[140:141], v[140:141], s[42:43]
    v_pk_mul_f32 v[142:143], v[142:143], s[42:43]
    v_pk_mul_f32 v[144:145], v[144:145], s[42:43]
    v_pk_mul_f32 v[146:147], v[146:147], s[42:43]
    v_pk_mul_f32 v[148:149], v[148:149], s[42:43]
    v_pk_mul_f32 v[150:151], v[150:151], s[42:43]
    v_pk_mul_f32 v[152:153], v[152:153], s[42:43]
    v_pk_mul_f32 v[154:155], v[154:155], s[42:43]
    v_pk_mul_f32 v[156:157], v[156:157], s[42:43]
    v_pk_mul_f32 v[158:159], v[158:159], s[42:43]
    v_pk_mul_f32 v[160:161], v[160:161], s[42:43]
    v_pk_mul_f32 v[162:163], v[162:163], s[42:43]
L1_pnoscale:
    s_waitcnt lgkmcnt(0)
    v_cvt_pk_bf16_f32 v164, v36, v37
    v_cvt_pk_bf16_f32 v165, v38, v39
    v_cvt_pk_bf16_f32 v166, v40, v41
    v_cvt_pk_bf16_f32 v167, v42, v43
    v_cvt_pk_bf16_f32 v168, v44, v45
    v_cvt_pk_bf16_f32 v169, v46, v47
    v_cvt_pk_bf16_f32 v170, v48, v49
    v_cvt_pk_bf16_f32 v171, v50, v51
    s_mov_b32 exec_lo, 0
    s_mov_b32 exec_hi, -1
    v_mov_b32 v170, s44
    v_mov_b32 v171, s45
    s_mov_b64 exec, -1
    s_add_u32 s28, s41, 0
    s_lshl_b32 s28, s28, s46
    s_add_u32 s28, s28, s29
    buffer_store_dwordx4 v[164:167], v2, s[16:19], s28 offen offset:0 sc1
    buffer_store_dwordx4 v[168:171], v2, s[16:19], s28 offen offset:1024 sc1
    v_cvt_pk_bf16_f32 v172, v52, v53
    v_cvt_pk_bf16_f32 v173, v54, v55
    v_cvt_pk_bf16_f32 v174, v56, v57
    v_cvt_pk_bf16_f32 v175, v58, v59
    v_cvt_pk_bf16_f32 v176, v60, v61
    v_cvt_pk_bf16_f32 v177, v62, v63
    v_cvt_pk_bf16_f32 v178, v64, v65
    v_cvt_pk_bf16_f32 v179, v66, v67
    s_mov_b32 exec_lo, 0
    s_mov_b32 exec_hi, -1
    v_mov_b32 v178, s44
    v_mov_b32 v179, s45
    s_mov_b64 exec, -1
    s_add_u32 s28, s41, 1
    s_lshl_b32 s28, s28, s46
    s_add_u32 s28, s28, s29
    buffer_store_dwordx4 v[172:175], v2, s[16:19], s28 offen offset:0 sc1
    buffer_store_dwordx4 v[176:179], v2, s[16:19], s28 offen offset:1024 sc1
    v_cvt_pk_bf16_f32 v180, v68, v69
    v_cvt_pk_bf16_f32 v181, v70, v71
    v_cvt_pk_bf16_f32 v182, v72, v73
    v_cvt_pk_bf16_f32 v183, v74, v75
    v_cvt_pk_bf16_f32 v184, v76, v77
    v_cvt_pk_bf16_f32 v185, v78, v79
    v_cvt_pk_bf16_f32 v186, v80, v81
    v_cvt_pk_bf16_f32 v187, v82, v83
    s_mov_b32 exec_lo, 0
    s_mov_b32 exec_hi, -1
    v_mov_b32 v186, s44
    v_mov_b32 v187, s45
    s_mov_b64 exec, -1
    s_add_u32 s28, s41, 64
    s_lshl_b32 s28, s28, s46
    s_add_u32 s28, s28, s29
    buffer_store_dwordx4 v[180:183], v2, s[16:19], s28 offen offset:0 sc1
    buffer_store_dwordx4 v[184:187], v2, s[16:19], s28 offen offset:1024 sc1
    v_cvt_pk_bf16_f32 v188, v84, v85
    v_cvt_pk_bf16_f32 v189, v86, v87
    v_cvt_pk_bf16_f32 v190, v88, v89
    v_cvt_pk_bf16_f32 v191, v90, v91
    v_cvt_pk_bf16_f32 v192, v92, v93
    v_cvt_pk_bf16_f32 v193, v94, v95
    v_cvt_pk_bf16_f32 v194, v96, v97
    v_cvt_pk_bf16_f32 v195, v98, v99
    s_mov_b32 exec_lo, 0
    s_mov_b32 exec_hi, -1
    v_mov_b32 v194, s44
    v_mov_b32 v195, s45
    s_mov_b64 exec, -1
    s_add_u32 s28, s41, 65
    s_lshl_b32 s28, s28, s46
    s_add_u32 s28, s28, s29
    buffer_store_dwordx4 v[188:191], v2, s[16:19], s28 offen offset:0 sc1
    buffer_store_dwordx4 v[192:195], v2, s[16:19], s28 offen offset:1024 sc1
    v_cvt_pk_bf16_f32 v196, v100, v101
    v_cvt_pk_bf16_f32 v197, v102, v103
    v_cvt_pk_bf16_f32 v198, v104, v105
    v_cvt_pk_bf16_f32 v199, v106, v107
    v_cvt_pk_bf16_f32 v200, v108, v109
    v_cvt_pk_bf16_f32 v201, v110, v111
    v_cvt_pk_bf16_f32 v202, v112, v113
    v_cvt_pk_bf16_f32 v203, v114, v115
    s_mov_b32 exec_lo, 0
    s_mov_b32 exec_hi, -1
    v_mov_b32 v202, s44
    v_mov_b32 v203, s45
    s_mov_b64 exec, -1
    s_add_u32 s28, s41, 128
    s_lshl_b32 s28, s28, s46
    s_add_u32 s28, s28, s29
    buffer_store_dwordx4 v[196:199], v2, s[16:19], s28 offen offset:0 sc1
    buffer_store_dwordx4 v[200:203], v2, s[16:19], s28 offen offset:1024 sc1
    v_cvt_pk_bf16_f32 v204, v116, v117
    v_cvt_pk_bf16_f32 v205, v118, v119
    v_cvt_pk_bf16_f32 v206, v120, v121
    v_cvt_pk_bf16_f32 v207, v122, v123
    v_cvt_pk_bf16_f32 v208, v124, v125
    v_cvt_pk_bf16_f32 v209, v126, v127
    v_cvt_pk_bf16_f32 v210, v128, v129
    v_cvt_pk_bf16_f32 v211, v130, v131
    s_mov_b32 exec_lo, 0
    s_mov_b32 exec_hi, -1
    v_mov_b32 v210, s44
    v_mov_b32 v211, s45
    s_mov_b64 exec, -1
    s_add_u32 s28, s41, 129
    s_lshl_b32 s28, s28, s46
    s_add_u32 s28, s28, s29
    buffer_store_dwordx4 v[204:207], v2, s[16:19], s28 offen offset:0 sc1
    buffer_store_dwordx4 v[208:211], v2, s[16:19], s28 offen offset:1024 sc1
    v_cvt_pk_bf16_f32 v164, v132, v133
    v_cvt_pk_bf16_f32 v165, v134, v135
    v_cvt_pk_bf16_f32 v166, v136, v137
    v_cvt_pk_bf16_f32 v167, v138, v139
    v_cvt_pk_bf16_f32 v168, v140, v141
    v_cvt_pk_bf16_f32 v169, v142, v143
    v_cvt_pk_bf16_f32 v170, v144, v145
    v_cvt_pk_bf16_f32 v171, v146, v147
    s_mov_b32 exec_lo, 0
    s_mov_b32 exec_hi, -1
    v_mov_b32 v170, s44
    v_mov_b32 v171, s45
    s_mov_b64 exec, -1
    s_add_u32 s28, s41, 192
    s_lshl_b32 s28, s28, s46
    s_add_u32 s28, s28, s29
    buffer_store_dwordx4 v[164:167], v2, s[16:19], s28 offen offset:0 sc1
    buffer_store_dwordx4 v[168:171], v2, s[16:19], s28 offen offset:1024 sc1
    v_cvt_pk_bf16_f32 v172, v148, v149
    v_cvt_pk_bf16_f32 v173, v150, v151
    v_cvt_pk_bf16_f32 v174, v152, v153
    v_cvt_pk_bf16_f32 v175, v154, v155
    v_cvt_pk_bf16_f32 v176, v156, v157
    v_cvt_pk_bf16_f32 v177, v158, v159
    v_cvt_pk_bf16_f32 v178, v160, v161
    v_cvt_pk_bf16_f32 v179, v162, v163
    s_mov_b32 exec_lo, 0
    s_mov_b32 exec_hi, -1
    v_mov_b32 v178, s44
    v_mov_b32 v179, s45
    s_mov_b64 exec, -1
    s_add_u32 s28, s41, 193
    s_lshl_b32 s28, s28, s46
    s_add_u32 s28, s28, s29
    buffer_store_dwordx4 v[172:175], v2, s[16:19], s28 offen offset:0 sc1
    buffer_store_dwordx4 v[176:179], v2, s[16:19], s28 offen offset:1024 sc1
    s_endpgm
.p2align 12
L1_pv:
    s_barrier
    ds_read_b128 v[164:167], v10 offset:0
    ds_read_b128 v[168:171], v10 offset:4096
    ds_read_b64_tr_b16 v[172:173], v22 offset:0
    ds_read_b64_tr_b16 v[174:175], v22 offset:1792
    ds_read_b64_tr_b16 v[176:177], v22 offset:56
    ds_read_b64_tr_b16 v[178:179], v22 offset:1848
    ds_read_b64_tr_b16 v[180:181], v22 offset:112
    ds_read_b64_tr_b16 v[182:183], v22 offset:1904
    ds_read_b64_tr_b16 v[184:185], v22 offset:168
    ds_read_b64_tr_b16 v[186:187], v22 offset:1960
L1_pvloop:
    s_waitcnt lgkmcnt(0)
    v_mfma_f32_32x32x16_bf16 v[36:51], v[164:167], v[172:175], v[36:51]
    ds_read_b128 v[188:191], v11 offset:0
    ds_read_b128 v[192:195], v11 offset:4096
    v_mfma_f32_32x32x16_bf16 v[52:67], v[168:171], v[172:175], v[52:67]
    ds_read_b64_tr_b16 v[196:197], v22 offset:7168
    ds_read_b64_tr_b16 v[198:199], v22 offset:8960
    v_mfma_f32_32x32x16_bf16 v[68:83], v[164:167], v[176:179], v[68:83]
    ds_read_b64_tr_b16 v[200:201], v22 offset:7224
    ds_read_b64_tr_b16 v[202:203], v22 offset:9016
    v_mfma_f32_32x32x16_bf16 v[84:99], v[168:171], v[176:179], v[84:99]
    ds_read_b64_tr_b16 v[204:205], v22 offset:7280
    ds_read_b64_tr_b16 v[206:207], v22 offset:9072
    v_mfma_f32_32x32x16_bf16 v[100:115], v[164:167], v[180:183], v[100:115]
    ds_read_b64_tr_b16 v[208:209], v22 offset:7336
    ds_read_b64_tr_b16 v[210:211], v22 offset:9128
    v_mfma_f32_32x32x16_bf16 v[116:131], v[168:171], v[180:183], v[116:131]
    s_add_u32 s36, s36, 1
    s_cmp_eq_u32 s36, 3
    v_mfma_f32_32x32x16_bf16 v[132:147], v[164:167], v[184:187], v[132:147]
    s_cselect_b32 s36, 0, s36
    s_cselect_b32 s33, 4294877184, 0
    v_mfma_f32_32x32x16_bf16 v[148:163], v[168:171], v[184:187], v[148:163]
    s_cselect_b32 s33, s33, 45056
    s_waitcnt lgkmcnt(0)
    v_mfma_f32_32x32x16_bf16 v[36:51], v[188:191], v[196:199], v[36:51]
    ds_read_b128 v[164:167], v12 offset:0
    ds_read_b128 v[168:171], v12 offset:4096
    v_mfma_f32_32x32x16_bf16 v[52:67], v[192:195], v[196:199], v[52:67]
    ds_read_b64_tr_b16 v[172:173], v22 offset:14336
    ds_read_b64_tr_b16 v[174:175], v22 offset:16128
    v_mfma_f32_32x32x16_bf16 v[68:83], v[188:191], v[200:203], v[68:83]
    ds_read_b64_tr_b16 v[176:177], v22 offset:14392
    ds_read_b64_tr_b16 v[178:179], v22 offset:16184
    v_mfma_f32_32x32x16_bf16 v[84:99], v[192:195], v[200:203], v[84:99]
    ds_read_b64_tr_b16 v[180:181], v22 offset:14448
    ds_read_b64_tr_b16 v[182:183], v22 offset:16240
    v_mfma_f32_32x32x16_bf16 v[100:115], v[188:191], v[204:207], v[100:115]
    ds_read_b64_tr_b16 v[184:185], v22 offset:14504
    ds_read_b64_tr_b16 v[186:187], v22 offset:16296
    v_mfma_f32_32x32x16_bf16 v[116:131], v[192:195], v[204:207], v[116:131]
    v_mfma_f32_32x32x16_bf16 v[132:147], v[188:191], v[208:211], v[132:147]
    v_mfma_f32_32x32x16_bf16 v[148:163], v[192:195], v[208:211], v[148:163]
    s_waitcnt lgkmcnt(0)
    v_mfma_f32_32x32x16_bf16 v[36:51], v[164:167], v[172:175], v[36:51]
    ds_read_b128 v[188:191], v13 offset:0
    ds_read_b128 v[192:195], v13 offset:4096
    v_mfma_f32_32x32x16_bf16 v[52:67], v[168:171], v[172:175], v[52:67]
    ds_read_b64_tr_b16 v[196:197], v22 offset:21504
    ds_read_b64_tr_b16 v[198:199], v22 offset:23296
    v_mfma_f32_32x32x16_bf16 v[68:83], v[164:167], v[176:179], v[68:83]
    ds_read_b64_tr_b16 v[200:201], v22 offset:21560
    ds_read_b64_tr_b16 v[202:203], v22 offset:23352
    v_mfma_f32_32x32x16_bf16 v[84:99], v[168:171], v[176:179], v[84:99]
    ds_read_b64_tr_b16 v[204:205], v22 offset:21616
    ds_read_b64_tr_b16 v[206:207], v22 offset:23408
    v_mfma_f32_32x32x16_bf16 v[100:115], v[164:167], v[180:183], v[100:115]
    ds_read_b64_tr_b16 v[208:209], v22 offset:21672
    ds_read_b64_tr_b16 v[210:211], v22 offset:23464
    v_mfma_f32_32x32x16_bf16 v[116:131], v[168:171], v[180:183], v[116:131]
    v_mfma_f32_32x32x16_bf16 v[132:147], v[164:167], v[184:187], v[132:147]
    v_mfma_f32_32x32x16_bf16 v[148:163], v[168:171], v[184:187], v[148:163]
    s_waitcnt lgkmcnt(0)
    s_barrier
    v_add_u32 v10, s33, v10
    v_add_u32 v11, s33, v11
    v_add_u32 v12, s33, v12
    v_add_u32 v13, s33, v13
    v_add_u32 v22, s33, v22
    v_mfma_f32_32x32x16_bf16 v[36:51], v[188:191], v[196:199], v[36:51]
    ds_read_b128 v[164:167], v10 offset:0
    ds_read_b128 v[168:171], v10 offset:4096
    v_mfma_f32_32x32x16_bf16 v[52:67], v[192:195], v[196:199], v[52:67]
    ds_read_b64_tr_b16 v[172:173], v22 offset:0
    ds_read_b64_tr_b16 v[174:175], v22 offset:1792
    v_mfma_f32_32x32x16_bf16 v[68:83], v[188:191], v[200:203], v[68:83]
    ds_read_b64_tr_b16 v[176:177], v22 offset:56
    ds_read_b64_tr_b16 v[178:179], v22 offset:1848
    v_mfma_f32_32x32x16_bf16 v[84:99], v[192:195], v[200:203], v[84:99]
    ds_read_b64_tr_b16 v[180:181], v22 offset:112
    ds_read_b64_tr_b16 v[182:183], v22 offset:1904
    v_mfma_f32_32x32x16_bf16 v[100:115], v[188:191], v[204:207], v[100:115]
    ds_read_b64_tr_b16 v[184:185], v22 offset:168
    ds_read_b64_tr_b16 v[186:187], v22 offset:1960
    v_mfma_f32_32x32x16_bf16 v[116:131], v[192:195], v[204:207], v[116:131]
    v_mfma_f32_32x32x16_bf16 v[132:147], v[188:191], v[208:211], v[132:147]
    s_sub_u32 s31, s31, 1
    s_cmp_lg_u32 s31, 0
    v_mfma_f32_32x32x16_bf16 v[148:163], v[192:195], v[208:211], v[148:163]
    s_cbranch_scc1 L1_pvloop
    s_waitcnt lgkmcnt(0)
    v_cvt_pk_bf16_f32 v164, v36, v37
    v_cvt_pk_bf16_f32 v165, v38, v39
    v_cvt_pk_bf16_f32 v166, v40, v41
    v_cvt_pk_bf16_f32 v167, v42, v43
    v_cvt_pk_bf16_f32 v168, v44, v45
    v_cvt_pk_bf16_f32 v169, v46, v47
    v_cvt_pk_bf16_f32 v170, v48, v49
    v_cvt_pk_bf16_f32 v171, v50, v51
    s_mov_b32 exec_lo, 0xf0000000
    s_mov_b32 exec_hi, 0xf0000000
    v_mov_b32 v164, v25
    v_mov_b32 v165, v25
    v_mov_b32 v166, v25
    v_mov_b32 v167, v25
    v_mov_b32 v168, v25
    v_mov_b32 v169, v25
    v_mov_b32 v170, v25
    v_mov_b32 v171, v25
    s_mov_b64 exec, -1
    s_add_u32 s28, s41, 0
    s_lshl_b32 s28, s28, 12
    buffer_store_dwordx4 v[164:167], v2, s[16:19], s28 offen offset:2048 sc1
    buffer_store_dwordx4 v[168:171], v2, s[16:19], s28 offen offset:3072 sc1
    v_cvt_pk_bf16_f32 v172, v52, v53
    v_cvt_pk_bf16_f32 v173, v54, v55
    v_cvt_pk_bf16_f32 v174, v56, v57
    v_cvt_pk_bf16_f32 v175, v58, v59
    v_cvt_pk_bf16_f32 v176, v60, v61
    v_cvt_pk_bf16_f32 v177, v62, v63
    v_cvt_pk_bf16_f32 v178, v64, v65
    v_cvt_pk_bf16_f32 v179, v66, v67
    s_mov_b32 exec_lo, 0xf0000000
    s_mov_b32 exec_hi, 0xf0000000
    v_mov_b32 v172, v25
    v_mov_b32 v173, v25
    v_mov_b32 v174, v25
    v_mov_b32 v175, v25
    v_mov_b32 v176, v25
    v_mov_b32 v177, v25
    v_mov_b32 v178, v25
    v_mov_b32 v179, v25
    s_mov_b64 exec, -1
    s_add_u32 s28, s41, 1
    s_lshl_b32 s28, s28, 12
    buffer_store_dwordx4 v[172:175], v2, s[16:19], s28 offen offset:2048 sc1
    buffer_store_dwordx4 v[176:179], v2, s[16:19], s28 offen offset:3072 sc1
    v_cvt_pk_bf16_f32 v180, v68, v69
    v_cvt_pk_bf16_f32 v181, v70, v71
    v_cvt_pk_bf16_f32 v182, v72, v73
    v_cvt_pk_bf16_f32 v183, v74, v75
    v_cvt_pk_bf16_f32 v184, v76, v77
    v_cvt_pk_bf16_f32 v185, v78, v79
    v_cvt_pk_bf16_f32 v186, v80, v81
    v_cvt_pk_bf16_f32 v187, v82, v83
    s_mov_b32 exec_lo, 0xf0000000
    s_mov_b32 exec_hi, 0xf0000000
    v_mov_b32 v180, v25
    v_mov_b32 v181, v25
    v_mov_b32 v182, v25
    v_mov_b32 v183, v25
    v_mov_b32 v184, v25
    v_mov_b32 v185, v25
    v_mov_b32 v186, v25
    v_mov_b32 v187, v25
    s_mov_b64 exec, -1
    s_add_u32 s28, s41, 64
    s_lshl_b32 s28, s28, 12
    buffer_store_dwordx4 v[180:183], v2, s[16:19], s28 offen offset:2048 sc1
    buffer_store_dwordx4 v[184:187], v2, s[16:19], s28 offen offset:3072 sc1
    v_cvt_pk_bf16_f32 v188, v84, v85
    v_cvt_pk_bf16_f32 v189, v86, v87
    v_cvt_pk_bf16_f32 v190, v88, v89
    v_cvt_pk_bf16_f32 v191, v90, v91
    v_cvt_pk_bf16_f32 v192, v92, v93
    v_cvt_pk_bf16_f32 v193, v94, v95
    v_cvt_pk_bf16_f32 v194, v96, v97
    v_cvt_pk_bf16_f32 v195, v98, v99
    s_mov_b32 exec_lo, 0xf0000000
    s_mov_b32 exec_hi, 0xf0000000
    v_mov_b32 v188, v25
    v_mov_b32 v189, v25
    v_mov_b32 v190, v25
    v_mov_b32 v191, v25
    v_mov_b32 v192, v25
    v_mov_b32 v193, v25
    v_mov_b32 v194, v25
    v_mov_b32 v195, v25
    s_mov_b64 exec, -1
    s_add_u32 s28, s41, 65
    s_lshl_b32 s28, s28, 12
    buffer_store_dwordx4 v[188:191], v2, s[16:19], s28 offen offset:2048 sc1
    buffer_store_dwordx4 v[192:195], v2, s[16:19], s28 offen offset:3072 sc1
    v_cvt_pk_bf16_f32 v196, v100, v101
    v_cvt_pk_bf16_f32 v197, v102, v103
    v_cvt_pk_bf16_f32 v198, v104, v105
    v_cvt_pk_bf16_f32 v199, v106, v107
    v_cvt_pk_bf16_f32 v200, v108, v109
    v_cvt_pk_bf16_f32 v201, v110, v111
    v_cvt_pk_bf16_f32 v202, v112, v113
    v_cvt_pk_bf16_f32 v203, v114, v115
    s_mov_b32 exec_lo, 0xf0000000
    s_mov_b32 exec_hi, 0xf0000000
    v_mov_b32 v196, v25
    v_mov_b32 v197, v25
    v_mov_b32 v198, v25
    v_mov_b32 v199, v25
    v_mov_b32 v200, v25
    v_mov_b32 v201, v25
    v_mov_b32 v202, v25
    v_mov_b32 v203, v25
    s_mov_b64 exec, -1
    s_add_u32 s28, s41, 128
    s_lshl_b32 s28, s28, 12
    buffer_store_dwordx4 v[196:199], v2, s[16:19], s28 offen offset:2048 sc1
    buffer_store_dwordx4 v[200:203], v2, s[16:19], s28 offen offset:3072 sc1
    v_cvt_pk_bf16_f32 v204, v116, v117
    v_cvt_pk_bf16_f32 v205, v118, v119
    v_cvt_pk_bf16_f32 v206, v120, v121
    v_cvt_pk_bf16_f32 v207, v122, v123
    v_cvt_pk_bf16_f32 v208, v124, v125
    v_cvt_pk_bf16_f32 v209, v126, v127
    v_cvt_pk_bf16_f32 v210, v128, v129
    v_cvt_pk_bf16_f32 v211, v130, v131
    s_mov_b32 exec_lo, 0xf0000000
    s_mov_b32 exec_hi, 0xf0000000
    v_mov_b32 v204, v25
    v_mov_b32 v205, v25
    v_mov_b32 v206, v25
    v_mov_b32 v207, v25
    v_mov_b32 v208, v25
    v_mov_b32 v209, v25
    v_mov_b32 v210, v25
    v_mov_b32 v211, v25
    s_mov_b64 exec, -1
    s_add_u32 s28, s41, 129
    s_lshl_b32 s28, s28, 12
    buffer_store_dwordx4 v[204:207], v2, s[16:19], s28 offen offset:2048 sc1
    buffer_store_dwordx4 v[208:211], v2, s[16:19], s28 offen offset:3072 sc1
    v_cvt_pk_bf16_f32 v164, v132, v133
    v_cvt_pk_bf16_f32 v165, v134, v135
    v_cvt_pk_bf16_f32 v166, v136, v137
    v_cvt_pk_bf16_f32 v167, v138, v139
    v_cvt_pk_bf16_f32 v168, v140, v141
    v_cvt_pk_bf16_f32 v169, v142, v143
    v_cvt_pk_bf16_f32 v170, v144, v145
    v_cvt_pk_bf16_f32 v171, v146, v147
    s_mov_b32 exec_lo, 0xf0000000
    s_mov_b32 exec_hi, 0xf0000000
    v_mov_b32 v164, v25
    v_mov_b32 v165, v25
    v_mov_b32 v166, v25
    v_mov_b32 v167, v25
    v_mov_b32 v168, v25
    v_mov_b32 v169, v25
    v_mov_b32 v170, v25
    v_mov_b32 v171, v25
    s_mov_b64 exec, -1
    s_add_u32 s28, s41, 192
    s_lshl_b32 s28, s28, 12
    buffer_store_dwordx4 v[164:167], v2, s[16:19], s28 offen offset:2048 sc1
    buffer_store_dwordx4 v[168:171], v2, s[16:19], s28 offen offset:3072 sc1
    v_cvt_pk_bf16_f32 v172, v148, v149
    v_cvt_pk_bf16_f32 v173, v150, v151
    v_cvt_pk_bf16_f32 v174, v152, v153
    v_cvt_pk_bf16_f32 v175, v154, v155
    v_cvt_pk_bf16_f32 v176, v156, v157
    v_cvt_pk_bf16_f32 v177, v158, v159
    v_cvt_pk_bf16_f32 v178, v160, v161
    v_cvt_pk_bf16_f32 v179, v162, v163
    s_mov_b32 exec_lo, 0xf0000000
    s_mov_b32 exec_hi, 0xf0000000
    v_mov_b32 v172, v25
    v_mov_b32 v173, v25
    v_mov_b32 v174, v25
    v_mov_b32 v175, v25
    v_mov_b32 v176, v25
    v_mov_b32 v177, v25
    v_mov_b32 v178, v25
    v_mov_b32 v179, v25
    s_mov_b64 exec, -1
    s_add_u32 s28, s41, 193
    s_lshl_b32 s28, s28, 12
    buffer_store_dwordx4 v[172:175], v2, s[16:19], s28 offen offset:2048 sc1
    buffer_store_dwordx4 v[176:179], v2, s[16:19], s28 offen offset:3072 sc1
    s_endpgm
L1_kset:
    s_mov_b32 s16, s8
    s_mov_b32 s17, s9
    s_mov_b32 s18, 0xf00000
    s_mov_b32 s19, 0x00020000
    s_and_b32 s29, s24, 3
    s_lshl_b32 s29, s29, 12
    s_add_u32 s29, s29, 16384
    s_lshr_b32 s28, s24, 2
    s_lshl_b32 s40, s26, 1
    s_add_u32 s40, s40, s28
    s_mul_i32 s41, s28, 1568
    s_add_u32 s41, s41, 131072
    s_mul_i32 s28, s28, 56
    s_mov_b32 s54, 0x3fb8aa3b
    s_mov_b32 s55, 0x3fb8aa3b
    v_and_b32 v28, 31, v1
    v_lshrrev_b32 v29, 5, v1
    v_bfe_u32 v30, v1, 1, 3
    v_xor_b32 v30, v30, v29
    v_lshlrev_b32 v31, 7, v28
    v_add_u32 v31, s29, v31
    v_lshl_add_u32 v10, v30, 4, v31
    v_xor_b32 v32, 2, v30
    v_lshl_add_u32 v11, v32, 4, v31
    v_xor_b32 v32, 4, v30
    v_lshl_add_u32 v12, v32, 4, v31
    v_xor_b32 v32, 6, v30
    v_lshl_add_u32 v13, v32, 4, v31
    v_bfe_u32 v30, v1, 4, 1
    v_lshlrev_b32 v31, 5, v30
    v_and_b32 v30, 3, v1
    v_lshl_add_u32 v31, v30, 3, v31
    v_bfe_u32 v30, v1, 2, 2
    v_lshl_add_u32 v32, v29, 3, v30
    v_mul_u32_u24 v32, 224, v32
    v_add3_u32 v22, v32, v31, s28
    v_mov_b32 v33, 0x3f803f80
    v_cmp_eq_u32 vcc, 28, v28
    v_add_u32 v14, 65536, v10
    v_add_u32 v15, 65536, v11
    v_add_u32 v16, 65536, v12
    v_add_u32 v17, 65536, v13
    v_add_u32 v23, 65536, v22
    v_cndmask_b32 v25, 0, v33, vcc
    v_lshl_add_u32 v32, v29, 2, v30
    v_mul_u32_u24 v32, 56, v32
    v_add3_u32 v26, v32, v31, s41
    v_lshlrev_b32 v30, 2, v29
    v_sub_u32 v30, v28, v30
    v_mov_b32 v31, 0x3f80
    v_mov_b32 v32, 0x3f800000
    v_cmp_eq_u32 vcc, 0, v30
    v_cmp_eq_u32 s[48:49], 1, v30
    s_nop 0
    v_cndmask_b32 v68, 0, v31, vcc
    v_cndmask_b32 v68, v68, v32, s[48:49]
    v_cmp_eq_u32 vcc, 2, v30
    v_cmp_eq_u32 s[48:49], 3, v30
    s_nop 0
    v_cndmask_b32 v69, 0, v31, vcc
    v_cndmask_b32 v69, v69, v32, s[48:49]
    v_cmp_eq_u32 vcc, 8, v30
    v_cmp_eq_u32 s[48:49], 9, v30
    s_nop 0
    v_cndmask_b32 v70, 0, v31, vcc
    v_cndmask_b32 v70, v70, v32, s[48:49]
    v_cmp_eq_u32 vcc, 10, v30
    v_cmp_eq_u32 s[48:49], 11, v30
    s_nop 0
    v_cndmask_b32 v71, 0, v31, vcc
    v_cndmask_b32 v71, v71, v32, s[48:49]
    v_cmp_eq_u32 vcc, 16, v30
    v_cmp_eq_u32 s[48:49], 17, v30
    s_nop 0
    v_cndmask_b32 v72, 0, v31, vcc
    v_cndmask_b32 v72, v72, v32, s[48:49]
    v_cmp_eq_u32 vcc, 18, v30
    v_cmp_eq_u32 s[48:49], 19, v30
    s_nop 0
    v_cndmask_b32 v73, 0, v31, vcc
    v_cndmask_b32 v73, v73, v32, s[48:49]
    v_cmp_eq_u32 vcc, 24, v30
    v_cmp_eq_u32 s[48:49], 25, v30
    s_nop 0
    v_cndmask_b32 v74, 0, v31, vcc
    v_cndmask_b32 v74, v74, v32, s[48:49]
    v_cmp_eq_u32 vcc, 26, v30
    v_cmp_eq_u32 s[48:49], 27, v30
    s_nop 0
    v_cndmask_b32 v75, 0, v31, vcc
    v_cndmask_b32 v75, v75, v32, s[48:49]
    v_mov_b32 v144, 0
    v_mov_b32 v160, 0
    v_mov_b32 v145, 0
    v_mov_b32 v161, 0
    v_mov_b32 v146, 0
    v_mov_b32 v162, 0
    v_mov_b32 v147, 0
    v_mov_b32 v163, 0
    s_branch L1_kmain
.p2align 12
L1_kmain:
    s_waitcnt vmcnt(4)
    s_barrier
    ds_read_b128 v[100:103], v10 offset:0
    ds_read_b64_tr_b16 v[116:117], v22 offset:0
    ds_read_b64_tr_b16 v[118:119], v22 offset:896
    ds_read_b64_tr_b16 v[120:121], v22 offset:112
    ds_read_b64_tr_b16 v[122:123], v22 offset:1008
    ds_read_b128 v[108:111], v11 offset:0
    ds_read_b64_tr_b16 v[124:125], v22 offset:3584
    ds_read_b64_tr_b16 v[126:127], v22 offset:4480
    ds_read_b64_tr_b16 v[128:129], v22 offset:3696
    ds_read_b64_tr_b16 v[130:131], v22 offset:4592
    s_waitcnt lgkmcnt(5)
    v_mfma_f32_32x32x16_bf16 v[36:51], v[116:119], v[100:103], 0
    s_add_u32 s31, s30, 2
    s_sub_u32 s28, s31, 4
    s_cmp_ge_u32 s31, 4
    s_cselect_b32 s31, s28, s31
    s_mul_i32 s36, s31, s33
    s_add_u32 s36, s36, s32
    s_add_u32 m0, s34, 65536
    s_nop 0
    buffer_load_dwordx4 v3, s[12:15], s36 offen lds
    v_mfma_f32_32x32x16_bf16 v[52:67], v[100:103], v[120:123], 0
    s_add_u32 m0, s34, 66560
    s_nop 0
    buffer_load_dwordx4 v4, s[12:15], s36 offen lds
    ds_read_b128 v[100:103], v12 offset:0
    ds_read_b64_tr_b16 v[116:117], v22 offset:7168
    ds_read_b64_tr_b16 v[118:119], v22 offset:8064
    ds_read_b64_tr_b16 v[120:121], v22 offset:7280
    ds_read_b64_tr_b16 v[122:123], v22 offset:8176
    s_waitcnt lgkmcnt(5)
    v_mfma_f32_32x32x16_bf16 v[36:51], v[124:127], v[108:111], v[36:51]
    s_add_u32 m0, s34, 67584
    s_nop 0
    buffer_load_dwordx4 v5, s[12:15], s36 offen lds
    v_mfma_f32_32x32x16_bf16 v[52:67], v[108:111], v[128:131], v[52:67]
    s_add_u32 m0, s34, 68608
    s_nop 0
    buffer_load_dwordx4 v6, s[12:15], s36 offen lds
    ds_read_b128 v[108:111], v13 offset:0
    ds_read_b64_tr_b16 v[124:125], v22 offset:10752
    ds_read_b64_tr_b16 v[126:127], v22 offset:11648
    ds_read_b64_tr_b16 v[128:129], v22 offset:10864
    ds_read_b64_tr_b16 v[130:131], v22 offset:11760
    s_waitcnt lgkmcnt(5)
    v_mfma_f32_32x32x16_bf16 v[36:51], v[116:119], v[100:103], v[36:51]
    s_add_u32 s31, s30, 3
    s_sub_u32 s28, s31, 4
    s_cmp_ge_u32 s31, 4
    s_cselect_b32 s31, s28, s31
    s_mul_i32 s36, s31, s33
    s_add_u32 s36, s36, s32
    s_add_u32 m0, s34, 98304
    s_nop 0
    buffer_load_dwordx4 v3, s[12:15], s36 offen lds
    v_mfma_f32_32x32x16_bf16 v[52:67], v[100:103], v[120:123], v[52:67]
    s_add_u32 m0, s34, 99328
    s_nop 0
    buffer_load_dwordx4 v4, s[12:15], s36 offen lds
    s_waitcnt lgkmcnt(0)
    s_waitcnt vmcnt(6)
    s_barrier
    ds_read_b128 v[100:103], v10 offset:32768
    ds_read_b64_tr_b16 v[116:117], v22 offset:32768
    ds_read_b64_tr_b16 v[118:119], v22 offset:33664
    ds_read_b64_tr_b16 v[120:121], v22 offset:32880
    ds_read_b64_tr_b16 v[122:123], v22 offset:33776
    v_mfma_f32_32x32x16_bf16 v[36:51], v[124:127], v[108:111], v[36:51]
    s_add_u32 m0, s34, 100352
    s_nop 0
    buffer_load_dwordx4 v5, s[12:15], s36 offen lds
    v_mfma_f32_32x32x16_bf16 v[52:67], v[108:111], v[128:131], v[52:67]
    s_add_u32 m0, s34, 101376
    s_nop 0
    buffer_load_dwordx4 v6, s[12:15], s36 offen lds
    ds_read_b128 v[108:111], v11 offset:32768
    ds_read_b64_tr_b16 v[124:125], v22 offset:36352
    ds_read_b64_tr_b16 v[126:127], v22 offset:37248
    ds_read_b64_tr_b16 v[128:129], v22 offset:36464
    ds_read_b64_tr_b16 v[130:131], v22 offset:37360
    s_waitcnt lgkmcnt(5)
    v_mfma_f32_32x32x16_bf16 v[36:51], v[116:119], v[100:103], v[36:51]
    s_add_u32 s31, s47, 4
    s_sub_u32 s28, s31, 3
    s_cmp_ge_u32 s31, 7
    s_cselect_b32 s31, s28, s31
    s_mul_i32 s36, s31, s33
    s_add_u32 s36, s36, s32
    s_add_u32 m0, s34, 0
    s_nop 0
    buffer_load_dwordx4 v3, s[12:15], s36 offen lds
    v_mfma_f32_32x32x16_bf16 v[52:67], v[100:103], v[120:123], v[52:67]
    s_add_u32 m0, s34, 1024
    s_nop 0
    buffer_load_dwordx4 v4, s[12:15], s36 offen lds
    ds_read_b128 v[100:103], v12 offset:32768
    ds_read_b64_tr_b16 v[116:117], v22 offset:39936
    ds_read_b64_tr_b16 v[118:119], v22 offset:40832
    ds_read_b64_tr_b16 v[120:121], v22 offset:40048
    ds_read_b64_tr_b16 v[122:123], v22 offset:40944
    s_waitcnt lgkmcnt(5)
    v_mfma_f32_32x32x16_bf16 v[36:51], v[124:127], v[108:111], v[36:51]
    s_add_u32 m0, s34, 2048
    s_nop 0
    buffer_load_dwordx4 v5, s[12:15], s36 offen lds
    v_mfma_f32_32x32x16_bf16 v[52:67], v[108:111], v[128:131], v[52:67]
    s_add_u32 m0, s34, 3072
    s_nop 0
    buffer_load_dwordx4 v6, s[12:15], s36 offen lds
    ds_read_b128 v[108:111], v13 offset:32768
    ds_read_b64_tr_b16 v[124:125], v22 offset:43520
    ds_read_b64_tr_b16 v[126:127], v22 offset:44416
    ds_read_b64_tr_b16 v[128:129], v22 offset:43632
    ds_read_b64_tr_b16 v[130:131], v22 offset:44528
    s_waitcnt lgkmcnt(5)
    v_mfma_f32_32x32x16_bf16 v[36:51], v[116:119], v[100:103], v[36:51]
    v_mfma_f32_32x32x16_bf16 v[52:67], v[100:103], v[120:123], v[52:67]
    s_waitcnt lgkmcnt(0)
    s_waitcnt vmcnt(8)
    s_barrier
    ds_read_b128 v[100:103], v14 offset:0
    ds_read_b64_tr_b16 v[116:117], v23 offset:0
    ds_read_b64_tr_b16 v[118:119], v23 offset:896
    ds_read_b64_tr_b16 v[120:121], v23 offset:112
    ds_read_b64_tr_b16 v[122:123], v23 offset:1008
    v_mfma_f32_32x32x16_bf16 v[36:51], v[124:127], v[108:111], v[36:51]
    s_add_u32 s31, s47, 5
    s_sub_u32 s28, s31, 3
    s_cmp_ge_u32 s31, 7
    s_cselect_b32 s31, s28, s31
    s_mul_i32 s36, s31, s33
    s_add_u32 s36, s36, s32
    s_add_u32 m0, s34, 32768
    s_nop 0
    buffer_load_dwordx4 v3, s[12:15], s36 offen lds
    v_mfma_f32_32x32x16_bf16 v[52:67], v[108:111], v[128:131], v[52:67]
    s_add_u32 m0, s34, 33792
    s_nop 0
    buffer_load_dwordx4 v4, s[12:15], s36 offen lds
    ds_read_b128 v[108:111], v15 offset:0
    ds_read_b64_tr_b16 v[124:125], v23 offset:3584
    ds_read_b64_tr_b16 v[126:127], v23 offset:4480
    ds_read_b64_tr_b16 v[128:129], v23 offset:3696
    ds_read_b64_tr_b16 v[130:131], v23 offset:4592
    s_waitcnt lgkmcnt(5)
    v_mfma_f32_32x32x16_bf16 v[36:51], v[116:119], v[100:103], v[36:51]
    s_add_u32 m0, s34, 34816
    s_nop 0
    buffer_load_dwordx4 v5, s[12:15], s36 offen lds
    v_mfma_f32_32x32x16_bf16 v[52:67], v[100:103], v[120:123], v[52:67]
    s_add_u32 m0, s34, 35840
    s_nop 0
    buffer_load_dwordx4 v6, s[12:15], s36 offen lds
    ds_read_b128 v[100:103], v16 offset:0
    ds_read_b64_tr_b16 v[116:117], v23 offset:7168
    ds_read_b64_tr_b16 v[118:119], v23 offset:8064
    ds_read_b64_tr_b16 v[120:121], v23 offset:7280
    ds_read_b64_tr_b16 v[122:123], v23 offset:8176
    s_waitcnt lgkmcnt(5)
    v_mfma_f32_32x32x16_bf16 v[36:51], v[124:127], v[108:111], v[36:51]
    v_mfma_f32_32x32x16_bf16 v[52:67], v[108:111], v[128:131], v[52:67]
    ds_read_b128 v[108:111], v17 offset:0
    ds_read_b64_tr_b16 v[124:125], v23 offset:10752
    ds_read_b64_tr_b16 v[126:127], v23 offset:11648
    ds_read_b64_tr_b16 v[128:129], v23 offset:10864
    ds_read_b64_tr_b16 v[130:131], v23 offset:11760
    s_waitcnt lgkmcnt(5)
    v_mfma_f32_32x32x16_bf16 v[36:51], v[116:119], v[100:103], v[36:51]
    v_mfma_f32_32x32x16_bf16 v[52:67], v[100:103], v[120:123], v[52:67]
    s_waitcnt lgkmcnt(0)
    s_waitcnt vmcnt(8)
    s_barrier
    ds_read_b128 v[100:103], v14 offset:32768
    ds_read_b64_tr_b16 v[116:117], v23 offset:32768
    ds_read_b64_tr_b16 v[118:119], v23 offset:33664
    ds_read_b64_tr_b16 v[120:121], v23 offset:32880
    ds_read_b64_tr_b16 v[122:123], v23 offset:33776
    v_mfma_f32_32x32x16_bf16 v[36:51], v[124:127], v[108:111], v[36:51]
    s_add_u32 s31, s47, 6
    s_sub_u32 s28, s31, 3
    s_cmp_ge_u32 s31, 7
    s_cselect_b32 s31, s28, s31
    s_mul_i32 s36, s31, s33
    s_add_u32 s36, s36, s32
    s_add_u32 m0, s34, 65536
    s_nop 0
    buffer_load_dwordx4 v3, s[12:15], s36 offen lds
    v_mfma_f32_32x32x16_bf16 v[52:67], v[108:111], v[128:131], v[52:67]
    s_add_u32 m0, s34, 66560
    s_nop 0
    buffer_load_dwordx4 v4, s[12:15], s36 offen lds
    ds_read_b128 v[108:111], v15 offset:32768
    ds_read_b64_tr_b16 v[124:125], v23 offset:36352
    ds_read_b64_tr_b16 v[126:127], v23 offset:37248
    ds_read_b64_tr_b16 v[128:129], v23 offset:36464
    ds_read_b64_tr_b16 v[130:131], v23 offset:37360
    s_waitcnt lgkmcnt(5)
    v_mfma_f32_32x32x16_bf16 v[36:51], v[116:119], v[100:103], v[36:51]
    s_add_u32 m0, s34, 67584
    s_nop 0
    buffer_load_dwordx4 v5, s[12:15], s36 offen lds
    v_mfma_f32_32x32x16_bf16 v[52:67], v[100:103], v[120:123], v[52:67]
    s_add_u32 m0, s34, 68608
    s_nop 0
    buffer_load_dwordx4 v6, s[12:15], s36 offen lds
    ds_read_b128 v[100:103], v16 offset:32768
    ds_read_b64_tr_b16 v[116:117], v23 offset:39936
    ds_read_b64_tr_b16 v[118:119], v23 offset:40832
    ds_read_b64_tr_b16 v[120:121], v23 offset:40048
    ds_read_b64_tr_b16 v[122:123], v23 offset:40944
    s_waitcnt lgkmcnt(5)
    v_mfma_f32_32x32x16_bf16 v[36:51], v[124:127], v[108:111], v[36:51]
    v_mfma_f32_32x32x16_bf16 v[52:67], v[108:111], v[128:131], v[52:67]
    ds_read_b128 v[108:111], v17 offset:32768
    ds_read_b64_tr_b16 v[124:125], v23 offset:43520
    ds_read_b64_tr_b16 v[126:127], v23 offset:44416
    ds_read_b64_tr_b16 v[128:129], v23 offset:43632
    ds_read_b64_tr_b16 v[130:131], v23 offset:44528
    s_waitcnt lgkmcnt(5)
    v_mfma_f32_32x32x16_bf16 v[36:51], v[116:119], v[100:103], v[36:51]
    v_mfma_f32_32x32x16_bf16 v[52:67], v[100:103], v[120:123], v[52:67]
    s_waitcnt lgkmcnt(0)
    s_waitcnt vmcnt(8)
    s_barrier
    ds_read_b128 v[100:103], v10 offset:0
    ds_read_b64_tr_b16 v[116:117], v22 offset:0
    ds_read_b64_tr_b16 v[118:119], v22 offset:896
    ds_read_b64_tr_b16 v[120:121], v22 offset:112
    ds_read_b64_tr_b16 v[122:123], v22 offset:1008
    v_mfma_f32_32x32x16_bf16 v[36:51], v[124:127], v[108:111], v[36:51]
    v_mfma_f32_32x32x16_bf16 v[52:67], v[108:111], v[128:131], v[52:67]
    ds_read_b128 v[108:111], v11 offset:0
    ds_read_b64_tr_b16 v[124:125], v22 offset:3584
    ds_read_b64_tr_b16 v[126:127], v22 offset:4480
    ds_read_b64_tr_b16 v[128:129], v22 offset:3696
    ds_read_b64_tr_b16 v[130:131], v22 offset:4592
    s_waitcnt lgkmcnt(5)
    v_mfma_f32_32x32x16_bf16 v[36:51], v[116:119], v[100:103], v[36:51]
    v_mfma_f32_32x32x16_bf16 v[52:67], v[100:103], v[120:123], v[52:67]
    ds_read_b128 v[100:103], v12 offset:0
    ds_read_b64_tr_b16 v[116:117], v22 offset:7168
    ds_read_b64_tr_b16 v[118:119], v22 offset:8064
    ds_read_b64_tr_b16 v[120:121], v22 offset:7280
    ds_read_b64_tr_b16 v[122:123], v22 offset:8176
    s_waitcnt lgkmcnt(5)
    v_mfma_f32_32x32x16_bf16 v[36:51], v[124:127], v[108:111], v[36:51]
    v_mfma_f32_32x32x16_bf16 v[52:67], v[108:111], v[128:131], v[52:67]
    ds_read_b128 v[108:111], v13 offset:0
    ds_read_b64_tr_b16 v[124:125], v22 offset:10752
    ds_read_b64_tr_b16 v[126:127], v22 offset:11648
    ds_read_b64_tr_b16 v[128:129], v22 offset:10864
    ds_read_b64_tr_b16 v[130:131], v22 offset:11760
    s_waitcnt lgkmcnt(5)
    v_mfma_f32_32x32x16_bf16 v[36:51], v[116:119], v[100:103], v[36:51]
    v_mfma_f32_32x32x16_bf16 v[52:67], v[100:103], v[120:123], v[52:67]
    s_waitcnt lgkmcnt(0)
    s_waitcnt vmcnt(4)
    s_barrier
    ds_read_b128 v[100:103], v10 offset:32768
    ds_read_b64_tr_b16 v[116:117], v22 offset:32768
    ds_read_b64_tr_b16 v[118:119], v22 offset:33664
    ds_read_b64_tr_b16 v[120:121], v22 offset:32880
    ds_read_b64_tr_b16 v[122:123], v22 offset:33776
    v_mfma_f32_32x32x16_bf16 v[36:51], v[124:127], v[108:111], v[36:51]
    v_mfma_f32_32x32x16_bf16 v[52:67], v[108:111], v[128:131], v[52:67]
    ds_read_b128 v[108:111], v11 offset:32768
    ds_read_b64_tr_b16 v[124:125], v22 offset:36352
    ds_read_b64_tr_b16 v[126:127], v22 offset:37248
    ds_read_b64_tr_b16 v[128:129], v22 offset:36464
    ds_read_b64_tr_b16 v[130:131], v22 offset:37360
    s_waitcnt lgkmcnt(5)
    v_mfma_f32_32x32x16_bf16 v[36:51], v[116:119], v[100:103], v[36:51]
    v_mfma_f32_32x32x16_bf16 v[52:67], v[100:103], v[120:123], v[52:67]
    ds_read_b128 v[100:103], v12 offset:32768
    ds_read_b64_tr_b16 v[116:117], v22 offset:39936
    ds_read_b64_tr_b16 v[118:119], v22 offset:40832
    ds_read_b64_tr_b16 v[120:121], v22 offset:40048
    ds_read_b64_tr_b16 v[122:123], v22 offset:40944
    s_waitcnt lgkmcnt(5)
    v_mfma_f32_32x32x16_bf16 v[36:51], v[124:127], v[108:111], v[36:51]
    v_mfma_f32_32x32x16_bf16 v[52:67], v[108:111], v[128:131], v[52:67]
    ds_read_b128 v[108:111], v13 offset:32768
    ds_read_b64_tr_b16 v[124:125], v22 offset:43520
    ds_read_b64_tr_b16 v[126:127], v22 offset:44416
    ds_read_b64_tr_b16 v[128:129], v22 offset:43632
    ds_read_b64_tr_b16 v[130:131], v22 offset:44528
    s_waitcnt lgkmcnt(5)
    v_mfma_f32_32x32x16_bf16 v[36:51], v[116:119], v[100:103], v[36:51]
    v_mfma_f32_32x32x16_bf16 v[52:67], v[100:103], v[120:123], v[52:67]
    s_waitcnt lgkmcnt(0)
    s_waitcnt vmcnt(0)
    s_barrier
    ds_read_b128 v[100:103], v14 offset:0
    ds_read_b64_tr_b16 v[116:117], v23 offset:0
    ds_read_b64_tr_b16 v[118:119], v23 offset:896
    ds_read_b64_tr_b16 v[120:121], v23 offset:112
    ds_read_b64_tr_b16 v[122:123], v23 offset:1008
    v_mfma_f32_32x32x16_bf16 v[36:51], v[124:127], v[108:111], v[36:51]
    v_mfma_f32_32x32x16_bf16 v[52:67], v[108:111], v[128:131], v[52:67]
    ds_read_b128 v[108:111], v15 offset:0
    ds_read_b64_tr_b16 v[124:125], v23 offset:3584
    ds_read_b64_tr_b16 v[126:127], v23 offset:4480
    ds_read_b64_tr_b16 v[128:129], v23 offset:3696
    ds_read_b64_tr_b16 v[130:131], v23 offset:4592
    s_waitcnt lgkmcnt(5)
    v_mfma_f32_32x32x16_bf16 v[36:51], v[116:119], v[100:103], v[36:51]
    v_mfma_f32_32x32x16_bf16 v[52:67], v[100:103], v[120:123], v[52:67]
    ds_read_b128 v[100:103], v16 offset:0
    ds_read_b64_tr_b16 v[116:117], v23 offset:7168
    ds_read_b64_tr_b16 v[118:119], v23 offset:8064
    ds_read_b64_tr_b16 v[120:121], v23 offset:7280
    ds_read_b64_tr_b16 v[122:123], v23 offset:8176
    s_waitcnt lgkmcnt(5)
    v_mfma_f32_32x32x16_bf16 v[36:51], v[124:127], v[108:111], v[36:51]
    v_mfma_f32_32x32x16_bf16 v[52:67], v[108:111], v[128:131], v[52:67]
    ds_read_b128 v[108:111], v17 offset:0
    ds_read_b64_tr_b16 v[124:125], v23 offset:10752
    ds_read_b64_tr_b16 v[126:127], v23 offset:11648
    ds_read_b64_tr_b16 v[128:129], v23 offset:10864
    ds_read_b64_tr_b16 v[130:131], v23 offset:11760
    s_waitcnt lgkmcnt(5)
    v_mfma_f32_32x32x16_bf16 v[36:51], v[116:119], v[100:103], v[36:51]
    v_mfma_f32_32x32x16_bf16 v[52:67], v[100:103], v[120:123], v[52:67]
    s_waitcnt lgkmcnt(0)
    v_mfma_f32_32x32x16_bf16 v[36:51], v[124:127], v[108:111], v[36:51]
    v_mfma_f32_32x32x16_bf16 v[52:67], v[108:111], v[128:131], v[52:67]
    ds_read_b64_tr_b16 v[76:77], v26 offset:0
    ds_read_b64_tr_b16 v[78:79], v26 offset:448
    ds_read_b64_tr_b16 v[80:81], v26 offset:896
    ds_read_b64_tr_b16 v[82:83], v26 offset:1344
    s_lshl_b32 s28, s2, 3
    s_add_u32 s28, s28, s24
    s_cmp_lg_u32 s28, 1024
    s_cbranch_scc1 L1_noid
    s_mov_b32 s28, 0xe10000
    buffer_store_dwordx4 v[68:71], v2, s[16:19], s28 offen offset:0 sc1
L1_noid:
    s_nop 0
    v_cvt_pk_bf16_f32 v100, v36, v37
    v_cvt_pk_bf16_f32 v101, v38, v39
    v_cvt_pk_bf16_f32 v102, v40, v41
    v_cvt_pk_bf16_f32 v103, v42, v43
    v_cvt_pk_bf16_f32 v104, v44, v45
    v_cvt_pk_bf16_f32 v105, v46, v47
    v_cvt_pk_bf16_f32 v106, v48, v49
    v_cvt_pk_bf16_f32 v107, v50, v51
    s_mov_b32 exec_lo, 0
    s_mov_b32 exec_hi, -1
    v_mov_b32 v106, 0
    v_mov_b32 v107, 0
    s_mov_b64 exec, -1
    s_waitcnt lgkmcnt(0)
    v_mfma_f32_32x32x16_bf16 v[36:51], v[76:79], v[100:103], 0
    v_mfma_f32_32x32x16_bf16 v[36:51], v[80:83], v[104:107], v[36:51]
    v_cvt_pk_bf16_f32 v108, v52, v53
    v_cvt_pk_bf16_f32 v109, v54, v55
    v_cvt_pk_bf16_f32 v110, v56, v57
    v_cvt_pk_bf16_f32 v111, v58, v59
    v_cvt_pk_bf16_f32 v112, v60, v61
    v_cvt_pk_bf16_f32 v113, v62, v63
    v_cvt_pk_bf16_f32 v114, v64, v65
    v_cvt_pk_bf16_f32 v115, v66, v67
    s_mov_b32 exec_lo, 0xf0000000
    s_mov_b32 exec_hi, 0xf0000000
    v_mov_b32 v108, v25
    v_mov_b32 v109, v25
    v_mov_b32 v110, v25
    v_mov_b32 v111, v25
    v_mov_b32 v112, v25
    v_mov_b32 v113, v25
    v_mov_b32 v114, v25
    v_mov_b32 v115, v25
    s_mov_b64 exec, -1
    v_max3_f32 v28, v36, v37, v38
    v_max3_f32 v28, v28, v39, v40
    v_max3_f32 v28, v28, v41, v42
    v_max3_f32 v28, v28, v43, v44
    v_max3_f32 v28, v28, v45, v46
    v_max_f32 v28, v28, v47
    v_min3_f32 v30, v36, v37, v38
    v_min3_f32 v30, v30, v39, v40
    v_min3_f32 v30, v30, v41, v42
    v_min3_f32 v30, v30, v43, v44
    v_min3_f32 v30, v30, v45, v46
    v_min_f32 v30, v30, v47
    s_mov_b64 exec, 0xffffffff
    v_max3_f32 v28, v28, v48, v49
    v_max3_f32 v28, v28, v50, v51
    v_min3_f32 v30, v30, v48, v49
    v_min3_f32 v30, v30, v50, v51
    s_mov_b64 exec, -1
    v_mov_b32 v32, v28
    v_mov_b32 v33, v30
    s_nop 0
    v_permlane32_swap_b32 v28, v32
    v_permlane32_swap_b32 v30, v33
    v_max_f32 v28, v28, v32
    v_min_f32 v30, v30, v33
    v_mul_f32 v28, s54, v28
    v_mul_f32 v30, s54, v30
    v_pk_fma_f32 v[132:133], v[36:37], s[54:55], v[28:29] op_sel_hi:[1,1,0] neg_lo:[0,0,1] neg_hi:[0,0,1]
    v_pk_fma_f32 v[148:149], v[36:37], s[54:55], v[30:31] op_sel_hi:[1,1,0] neg_lo:[1,0,0] neg_hi:[1,0,0]
    v_pk_fma_f32 v[134:135], v[38:39], s[54:55], v[28:29] op_sel_hi:[1,1,0] neg_lo:[0,0,1] neg_hi:[0,0,1]
    v_pk_fma_f32 v[150:151], v[38:39], s[54:55], v[30:31] op_sel_hi:[1,1,0] neg_lo:[1,0,0] neg_hi:[1,0,0]
    v_pk_fma_f32 v[136:137], v[40:41], s[54:55], v[28:29] op_sel_hi:[1,1,0] neg_lo:[0,0,1] neg_hi:[0,0,1]
    v_pk_fma_f32 v[152:153], v[40:41], s[54:55], v[30:31] op_sel_hi:[1,1,0] neg_lo:[1,0,0] neg_hi:[1,0,0]
    v_pk_fma_f32 v[138:139], v[42:43], s[54:55], v[28:29] op_sel_hi:[1,1,0] neg_lo:[0,0,1] neg_hi:[0,0,1]
    v_pk_fma_f32 v[154:155], v[42:43], s[54:55], v[30:31] op_sel_hi:[1,1,0] neg_lo:[1,0,0] neg_hi:[1,0,0]
    v_pk_fma_f32 v[140:141], v[44:45], s[54:55], v[28:29] op_sel_hi:[1,1,0] neg_lo:[0,0,1] neg_hi:[0,0,1]
    v_pk_fma_f32 v[156:157], v[44:45], s[54:55], v[30:31] op_sel_hi:[1,1,0] neg_lo:[1,0,0] neg_hi:[1,0,0]
    v_pk_fma_f32 v[142:143], v[46:47], s[54:55], v[28:29] op_sel_hi:[1,1,0] neg_lo:[0,0,1] neg_hi:[0,0,1]
    v_pk_fma_f32 v[158:159], v[46:47], s[54:55], v[30:31] op_sel_hi:[1,1,0] neg_lo:[1,0,0] neg_hi:[1,0,0]
    s_mov_b64 exec, 0xffffffff
    v_pk_fma_f32 v[144:145], v[48:49], s[54:55], v[28:29] op_sel_hi:[1,1,0] neg_lo:[0,0,1] neg_hi:[0,0,1]
    v_pk_fma_f32 v[160:161], v[48:49], s[54:55], v[30:31] op_sel_hi:[1,1,0] neg_lo:[1,0,0] neg_hi:[1,0,0]
    v_pk_fma_f32 v[146:147], v[50:51], s[54:55], v[28:29] op_sel_hi:[1,1,0] neg_lo:[0,0,1] neg_hi:[0,0,1]
    v_pk_fma_f32 v[162:163], v[50:51], s[54:55], v[30:31] op_sel_hi:[1,1,0] neg_lo:[1,0,0] neg_hi:[1,0,0]
    v_exp_f32 v144, v144
    v_exp_f32 v160, v160
    v_exp_f32 v145, v145
    v_exp_f32 v161, v161
    v_exp_f32 v146, v146
    v_exp_f32 v162, v162
    v_exp_f32 v147, v147
    v_exp_f32 v163, v163
    s_mov_b64 exec, -1
    v_exp_f32 v132, v132
    v_exp_f32 v148, v148
    v_exp_f32 v133, v133
    v_exp_f32 v149, v149
    v_exp_f32 v134, v134
    v_exp_f32 v150, v150
    v_exp_f32 v135, v135
    v_exp_f32 v151, v151
    v_exp_f32 v136, v136
    v_exp_f32 v152, v152
    v_exp_f32 v137, v137
    v_exp_f32 v153, v153
    v_exp_f32 v138, v138
    v_exp_f32 v154, v154
    v_exp_f32 v139, v139
    v_exp_f32 v155, v155
    v_exp_f32 v140, v140
    v_exp_f32 v156, v156
    v_exp_f32 v141, v141
    v_exp_f32 v157, v157
    v_exp_f32 v142, v142
    v_exp_f32 v158, v158
    v_exp_f32 v143, v143
    v_exp_f32 v159, v159
    v_pk_add_f32 v[28:29], v[144:145], v[146:147]
    v_pk_add_f32 v[28:29], v[28:29], v[132:133]
    v_pk_add_f32 v[28:29], v[28:29], v[134:135]
    v_pk_add_f32 v[28:29], v[28:29], v[136:137]
    v_pk_add_f32 v[28:29], v[28:29], v[138:139]
    v_pk_add_f32 v[28:29], v[28:29], v[140:141]
    v_pk_add_f32 v[28:29], v[28:29], v[142:143]
    v_add_f32 v28, v28, v29
    v_pk_add_f32 v[30:31], v[160:161], v[162:163]
    v_pk_add_f32 v[30:31], v[30:31], v[148:149]
    v_pk_add_f32 v[30:31], v[30:31], v[150:151]
    v_pk_add_f32 v[30:31], v[30:31], v[152:153]
    v_pk_add_f32 v[30:31], v[30:31], v[154:155]
    v_pk_add_f32 v[30:31], v[30:31], v[156:157]
    v_pk_add_f32 v[30:31], v[30:31], v[158:159]
    v_add_f32 v30, v30, v31
    v_mov_b32 v32, v28
    v_mov_b32 v33, v30
    s_nop 0
    v_permlane32_swap_b32 v28, v32
    v_permlane32_swap_b32 v30, v33
    v_add_f32 v28, v28, v32
    v_add_f32 v30, v30, v33
    v_rcp_f32 v28, v28
    v_rcp_f32 v30, v30
    v_pk_mul_f32 v[132:133], v[132:133], v[28:29] op_sel_hi:[1,0]
    v_pk_mul_f32 v[134:135], v[134:135], v[28:29] op_sel_hi:[1,0]
    v_pk_mul_f32 v[136:137], v[136:137], v[28:29] op_sel_hi:[1,0]
    v_pk_mul_f32 v[138:139], v[138:139], v[28:29] op_sel_hi:[1,0]
    v_pk_mul_f32 v[140:141], v[140:141], v[28:29] op_sel_hi:[1,0]
    v_pk_mul_f32 v[142:143], v[142:143], v[28:29] op_sel_hi:[1,0]
    v_pk_mul_f32 v[144:145], v[144:145], v[28:29] op_sel_hi:[1,0]
    v_pk_mul_f32 v[146:147], v[146:147], v[28:29] op_sel_hi:[1,0]
    v_cvt_pk_bf16_f32 v116, v132, v133
    v_cvt_pk_bf16_f32 v117, v134, v135
    v_cvt_pk_bf16_f32 v118, v136, v137
    v_cvt_pk_bf16_f32 v119, v138, v139
    v_cvt_pk_bf16_f32 v120, v140, v141
    v_cvt_pk_bf16_f32 v121, v142, v143
    v_cvt_pk_bf16_f32 v122, v144, v145
    v_cvt_pk_bf16_f32 v123, v146, v147
    v_pk_mul_f32 v[148:149], v[148:149], v[30:31] op_sel_hi:[1,0]
    v_pk_mul_f32 v[150:151], v[150:151], v[30:31] op_sel_hi:[1,0]
    v_pk_mul_f32 v[152:153], v[152:153], v[30:31] op_sel_hi:[1,0]
    v_pk_mul_f32 v[154:155], v[154:155], v[30:31] op_sel_hi:[1,0]
    v_pk_mul_f32 v[156:157], v[156:157], v[30:31] op_sel_hi:[1,0]
    v_pk_mul_f32 v[158:159], v[158:159], v[30:31] op_sel_hi:[1,0]
    v_pk_mul_f32 v[160:161], v[160:161], v[30:31] op_sel_hi:[1,0]
    v_pk_mul_f32 v[162:163], v[162:163], v[30:31] op_sel_hi:[1,0]
    v_cvt_pk_bf16_f32 v124, v148, v149
    v_cvt_pk_bf16_f32 v125, v150, v151
    v_cvt_pk_bf16_f32 v126, v152, v153
    v_cvt_pk_bf16_f32 v127, v154, v155
    v_cvt_pk_bf16_f32 v128, v156, v157
    v_cvt_pk_bf16_f32 v129, v158, v159
    v_cvt_pk_bf16_f32 v130, v160, v161
    v_cvt_pk_bf16_f32 v131, v162, v163
    v_mfma_f32_32x32x16_bf16 v[36:51], v[116:119], v[68:71], 0
    v_mfma_f32_32x32x16_bf16 v[36:51], v[120:123], v[72:75], v[36:51]
    v_mfma_f32_32x32x16_bf16 v[52:67], v[124:127], v[68:71], 0
    v_mfma_f32_32x32x16_bf16 v[52:67], v[128:131], v[72:75], v[52:67]
    s_lshl_b32 s28, s24, 13
    v_add_u32 v28, s28, v2
    s_and_b32 s29, s24, 3
    s_lshl_b32 s29, s29, 11
    s_and_b32 s28, s24, 4
    s_lshl_b32 s28, s28, 13
    s_add_u32 s28, s28, s29
    v_add_u32 v29, s28, v2
    s_lshl_b32 s28, s40, 4
    s_add_u32 s28, s28, s27
    s_lshl_b32 s28, s28, 13
    s_add_u32 s28, s28, s29
    s_lshr_b32 s28, s28, 1
    s_add_u32 s28, s28, 0x800000
    v_cvt_pk_bf16_f32 v116, v36, v37
    v_cvt_pk_bf16_f32 v117, v38, v39
    v_cvt_pk_bf16_f32 v118, v40, v41
    v_cvt_pk_bf16_f32 v119, v42, v43
    v_cvt_pk_bf16_f32 v120, v44, v45
    v_cvt_pk_bf16_f32 v121, v46, v47
    v_cvt_pk_bf16_f32 v122, v48, v49
    v_cvt_pk_bf16_f32 v123, v50, v51
    v_mfma_f32_32x32x16_bf16 v[132:147], v[116:119], v[108:111], 0
    s_nop 0
    v_mfma_f32_32x32x16_bf16 v[132:147], v[120:123], v[112:115], v[132:147]
    v_cvt_pk_bf16_f32 v124, v52, v53
    v_cvt_pk_bf16_f32 v125, v54, v55
    v_cvt_pk_bf16_f32 v126, v56, v57
    v_cvt_pk_bf16_f32 v127, v58, v59
    v_cvt_pk_bf16_f32 v128, v60, v61
    v_cvt_pk_bf16_f32 v129, v62, v63
    v_cvt_pk_bf16_f32 v130, v64, v65
    v_cvt_pk_bf16_f32 v131, v66, v67
    v_mfma_f32_32x32x16_bf16 v[148:163], v[124:127], v[108:111], 0
    s_nop 0
    v_mfma_f32_32x32x16_bf16 v[148:163], v[128:131], v[112:115], v[148:163]
    s_nop 0
    ds_write_b128 v28, v[132:135] offset:0
    ds_write_b128 v28, v[136:139] offset:1024
    ds_write_b128 v28, v[140:143] offset:2048
    ds_write_b128 v28, v[144:147] offset:3072
    s_nop 6
    ds_write_b128 v28, v[148:151] offset:4096
    ds_write_b128 v28, v[152:155] offset:5120
    ds_write_b128 v28, v[156:159] offset:6144
    ds_write_b128 v28, v[160:163] offset:7168
    s_waitcnt lgkmcnt(0)
    s_barrier
    ds_read_b128 v[36:39], v29 offset:0
    ds_read_b128 v[40:43], v29 offset:1024
    ds_read_b128 v[44:47], v29 offset:8192
    ds_read_b128 v[48:51], v29 offset:9216
    ds_read_b128 v[52:55], v29 offset:16384
    ds_read_b128 v[56:59], v29 offset:17408
    ds_read_b128 v[60:63], v29 offset:24576
    ds_read_b128 v[64:67], v29 offset:25600
    s_waitcnt lgkmcnt(4)
    v_pk_add_f32 v[36:37], v[36:37], v[44:45]
    v_pk_add_f32 v[38:39], v[38:39], v[46:47]
    v_pk_add_f32 v[40:41], v[40:41], v[48:49]
    v_pk_add_f32 v[42:43], v[42:43], v[50:51]
    s_waitcnt lgkmcnt(2)
    v_pk_add_f32 v[36:37], v[36:37], v[52:53]
    v_pk_add_f32 v[38:39], v[38:39], v[54:55]
    v_pk_add_f32 v[40:41], v[40:41], v[56:57]
    v_pk_add_f32 v[42:43], v[42:43], v[58:59]
    s_waitcnt lgkmcnt(0)
    v_pk_add_f32 v[36:37], v[36:37], v[60:61]
    v_pk_add_f32 v[38:39], v[38:39], v[62:63]
    v_pk_add_f32 v[40:41], v[40:41], v[64:65]
    v_pk_add_f32 v[42:43], v[42:43], v[66:67]
    v_cvt_pk_bf16_f32 v44, v36, v37
    v_cvt_pk_bf16_f32 v45, v38, v39
    v_cvt_pk_bf16_f32 v46, v40, v41
    v_cvt_pk_bf16_f32 v47, v42, v43
    buffer_store_dwordx4 v[44:47], v2, s[16:19], s28 offen offset:0 sc1
L1_end:
    s_endpgm
.globl attn_kernel
.p2align 12
.type attn_kernel,@function
attn_kernel:
    s_load_dwordx2 s[4:5], s[0:1], 72
    s_cmp_ge_u32 s2, 256
    s_cbranch_scc1 L2_end
    v_lshrrev_b32 v2, 6, v0
    v_and_b32 v1, 63, v0
    v_lshlrev_b32 v1, 4, v1
    v_readfirstlane_b32 s8, v2
    s_and_b32 s9, s2, 7
    s_lshl_b32 s9, s9, 1
    s_lshr_b32 s10, s2, 7
    s_add_u32 s9, s9, s10
    s_bfe_u32 s11, s2, 0x40003
    s_lshl_b32 s11, s11, 2
    s_mov_b32 s6, 0xf00000
    s_mov_b32 s7, 0x00020000
    s_cmp_ge_u32 s8, 4
    s_cbranch_scc1 L2_help
    s_load_dwordx2 s[24:25], s[0:1], 56
    s_lshr_b32 s12, s8, 1
    s_and_b32 s10, s8, 1
    s_lshl_b32 s10, s10, 1
    s_add_u32 s11, s11, s10
    s_add_u32 s11, s11, s12
    s_lshl_b32 s10, s9, 6
    s_add_u32 s10, s11, s10
    s_lshl_b32 s10, s10, 11
    s_add_u32 s10, s10, 0x400000
    s_xor_b32 s21, s10, 0x800
    s_lshl_b32 s13, s9, 18
    s_lshl_b32 s14, s12, 17
    s_add_u32 s14, s13, s14
    s_waitcnt lgkmcnt(0)
    buffer_load_dwordx4 a[48:51], v1, s[4:7], s13 offen offset:0
    buffer_load_dwordx4 a[52:55], v1, s[4:7], s13 offen offset:1024
    buffer_load_dwordx4 v[4:7], v1, s[4:7], s21 offen offset:0
    buffer_load_dwordx4 v[8:11], v1, s[4:7], s21 offen offset:1024
    buffer_load_dwordx4 v[12:15], v1, s[4:7], s10 offen offset:0
    buffer_load_dwordx4 v[16:19], v1, s[4:7], s10 offen offset:1024
    buffer_load_dwordx4 a[0:3], v1, s[4:7], s14 offen offset:0
    buffer_load_dwordx4 a[4:7], v1, s[4:7], s14 offen offset:1024
    buffer_load_dwordx4 a[8:11], v1, s[4:7], s14 offen offset:2048
    buffer_load_dwordx4 a[12:15], v1, s[4:7], s14 offen offset:3072
    s_add_u32 s14, s14, 4096
    buffer_load_dwordx4 a[16:19], v1, s[4:7], s14 offen offset:0
    buffer_load_dwordx4 a[20:23], v1, s[4:7], s14 offen offset:1024
    buffer_load_dwordx4 a[24:27], v1, s[4:7], s14 offen offset:2048
    buffer_load_dwordx4 a[28:31], v1, s[4:7], s14 offen offset:3072
    s_add_u32 s14, s14, 4096
    buffer_load_dwordx4 a[32:35], v1, s[4:7], s14 offen offset:0
    buffer_load_dwordx4 a[36:39], v1, s[4:7], s14 offen offset:1024
    buffer_load_dwordx4 a[40:43], v1, s[4:7], s14 offen offset:2048
    buffer_load_dwordx4 a[44:47], v1, s[4:7], s14 offen offset:3072
    s_add_u32 s14, s14, 4096
    v_mov_b32 v60, 0
    v_mov_b32 v61, 0
    v_mov_b32 v62, 0
    v_mov_b32 v63, 0
    v_mov_b32 v64, 0
    v_mov_b32 v65, 0
    v_mov_b32 v66, 0
    v_mov_b32 v67, 0
    v_accvgpr_write_b32 a56, 0
    v_accvgpr_write_b32 a57, 0
    v_accvgpr_write_b32 a58, 0
    v_accvgpr_write_b32 a59, 0
    v_accvgpr_write_b32 a60, 0
    v_accvgpr_write_b32 a61, 0
    v_accvgpr_write_b32 a62, 0
    v_accvgpr_write_b32 a63, 0
    v_mfma_f32_32x32x16_bf16 v[68:83], v[60:63], v[60:63], 0
    v_mfma_f32_32x32x16_bf16 v[84:99], v[60:63], v[60:63], 0
    s_barrier
    s_mov_b32 s15, 0xffff0000
    s_lshl_b32 s10, s11, 4
    s_add_u32 s10, s10, s9
    s_lshl_b32 s10, s10, 11
    s_add_u32 s19, s10, 0xa00000
    s_lshl_b32 s10, s8, 12
    v_add_u32 v3, s10, v1
    s_xor_b32 s10, s10, 0x2000
    v_add_u32 v2, s10, v1
    s_mov_b32 s16, 7
    s_waitcnt vmcnt(12)
    v_mfma_f32_32x32x16_bf16 v[20:35], a[48:51], v[4:7], 0
    v_mfma_f32_32x32x16_bf16 v[20:35], a[52:55], v[8:11], v[20:35]
    v_mfma_f32_32x32x16_bf16 v[36:51], a[48:51], v[12:15], 0
    v_mfma_f32_32x32x16_bf16 v[36:51], a[52:55], v[16:19], v[36:51]
    buffer_load_dwordx4 a[48:51], v1, s[4:7], s14 offen offset:0
    s_add_u32 s14, s14, -2048
    s_nop 7
    v_max3_f32 v100, v20, v21, v22
    v_max3_f32 v100, v100, v23, v24
    v_max3_f32 v100, v100, v25, v26
    v_max3_f32 v100, v100, v27, v28
    v_max3_f32 v100, v100, v29, v30
    v_max3_f32 v100, v100, v31, v32
    v_max3_f32 v100, v100, v33, v34
    v_max_f32 v100, v100, v35
    v_mov_b32 v101, v100
    s_nop 1
    v_permlane32_swap_b32 v100, v101
    v_max_f32 v100, v100, v101
    v_add_f32 v100, 0x42200000, v100
    v_and_b32 v101, s15, v100
    v_sub_f32 v100, v100, v101
    v_and_b32 v102, s15, v100
    v_sub_f32 v100, v100, v102
    s_mov_b32 exec_lo, 0
    s_mov_b32 exec_hi, -1
    v_cvt_pk_bf16_f32 v10, -v101, -v102
    v_cvt_pk_bf16_f32 v11, -v100, 0
    s_mov_b64 exec, -1
    s_waitcnt vmcnt(11)
    v_mfma_f32_32x32x16_bf16 v[20:35], a[0:3], v[4:7], 0
    v_mfma_f32_32x32x16_bf16 v[20:35], a[4:7], v[8:11], v[20:35]
    v_max3_f32 v104, v36, v37, v38
    v_max3_f32 v104, v104, v39, v40
    v_max3_f32 v104, v104, v41, v42
    v_max3_f32 v104, v104, v43, v44
    v_max3_f32 v104, v104, v45, v46
    v_max3_f32 v104, v104, v47, v48
    v_max3_f32 v104, v104, v49, v50
    v_max_f32 v104, v104, v51
    v_mov_b32 v105, v104
    s_nop 1
    v_permlane32_swap_b32 v104, v105
    v_max_f32 v104, v104, v105
    v_add_f32 v104, 0x42200000, v104
    v_and_b32 v105, s15, v104
    v_sub_f32 v104, v104, v105
    v_and_b32 v106, s15, v104
    v_sub_f32 v104, v104, v106
    s_mov_b32 exec_lo, 0
    s_mov_b32 exec_hi, -1
    v_cvt_pk_bf16_f32 v18, -v105, -v106
    v_cvt_pk_bf16_f32 v19, -v104, 0
    s_mov_b64 exec, -1
L2_loop:
    v_mfma_f32_32x32x16_bf16 v[36:51], a[0:3], v[12:15], 0
    buffer_load_dwordx4 a[52:55], v1, s[4:7], s14 offen offset:3072
    v_exp_f32 v20, v20
    v_exp_f32 v21, v21
    v_exp_f32 v22, v22
    v_exp_f32 v23, v23
    v_cvt_pk_bf16_f32 v52, v20, v21
    v_mfma_f32_32x32x16_bf16 v[36:51], a[4:7], v[16:19], v[36:51]
    s_add_u32 s14, s14, 4096
    v_exp_f32 v24, v24
    v_exp_f32 v25, v25
    v_cvt_pk_bf16_f32 v53, v22, v23
    v_exp_f32 v26, v26
    v_exp_f32 v27, v27
    v_cvt_pk_bf16_f32 v54, v24, v25
    v_mfma_f32_32x32x16_bf16 v[84:99], a[56:59], v[60:63], v[84:99]
    buffer_load_dwordx4 a[0:3], v1, s[4:7], s14 offen offset:2048
    v_exp_f32 v28, v28
    v_exp_f32 v29, v29
    v_cvt_pk_bf16_f32 v55, v26, v27
    v_exp_f32 v30, v30
    v_exp_f32 v31, v31
    v_cvt_pk_bf16_f32 v56, v28, v29
    v_mfma_f32_32x32x16_bf16 v[84:99], a[60:63], v[64:67], v[84:99]
    s_waitcnt vmcnt(9)
    v_exp_f32 v32, v32
    v_exp_f32 v33, v33
    v_cvt_pk_bf16_f32 v57, v30, v31
    v_exp_f32 v34, v34
    v_exp_f32 v35, v35
    v_cvt_pk_bf16_f32 v58, v32, v33
    v_cvt_pk_bf16_f32 v59, v34, v35
    v_mfma_f32_32x32x16_bf16 v[20:35], a[16:19], v[4:7], 0
    buffer_load_dwordx4 a[56:59], v1, s[4:7], s14 offen offset:0
    v_exp_f32 v36, v36
    v_exp_f32 v37, v37
    v_exp_f32 v38, v38
    v_exp_f32 v39, v39
    v_cvt_pk_bf16_f32 v60, v36, v37
    v_mfma_f32_32x32x16_bf16 v[20:35], a[20:23], v[8:11], v[20:35]
    v_exp_f32 v40, v40
    v_exp_f32 v41, v41
    v_cvt_pk_bf16_f32 v61, v38, v39
    v_exp_f32 v42, v42
    v_exp_f32 v43, v43
    v_cvt_pk_bf16_f32 v62, v40, v41
    v_mfma_f32_32x32x16_bf16 v[68:83], a[8:11], v[52:55], v[68:83]
    buffer_load_dwordx4 a[60:63], v1, s[4:7], s14 offen offset:1024
    v_exp_f32 v44, v44
    v_exp_f32 v45, v45
    v_cvt_pk_bf16_f32 v63, v42, v43
    v_exp_f32 v46, v46
    v_exp_f32 v47, v47
    v_cvt_pk_bf16_f32 v64, v44, v45
    v_mfma_f32_32x32x16_bf16 v[68:83], a[12:15], v[56:59], v[68:83]
    v_exp_f32 v48, v48
    v_exp_f32 v49, v49
    v_cvt_pk_bf16_f32 v65, v46, v47
    v_exp_f32 v50, v50
    v_exp_f32 v51, v51
    v_cvt_pk_bf16_f32 v66, v48, v49
    v_cvt_pk_bf16_f32 v67, v50, v51
    v_mfma_f32_32x32x16_bf16 v[36:51], a[16:19], v[12:15], 0
    buffer_load_dwordx4 a[4:7], v1, s[4:7], s14 offen offset:3072
    v_exp_f32 v20, v20
    v_exp_f32 v21, v21
    v_exp_f32 v22, v22
    v_exp_f32 v23, v23
    v_cvt_pk_bf16_f32 v52, v20, v21
    v_mfma_f32_32x32x16_bf16 v[36:51], a[20:23], v[16:19], v[36:51]
    s_add_u32 s14, s14, 4096
    v_exp_f32 v24, v24
    v_exp_f32 v25, v25
    v_cvt_pk_bf16_f32 v53, v22, v23
    v_exp_f32 v26, v26
    v_exp_f32 v27, v27
    v_cvt_pk_bf16_f32 v54, v24, v25
    v_mfma_f32_32x32x16_bf16 v[84:99], a[8:11], v[60:63], v[84:99]
    buffer_load_dwordx4 a[16:19], v1, s[4:7], s14 offen offset:2048
    v_exp_f32 v28, v28
    v_exp_f32 v29, v29
    v_cvt_pk_bf16_f32 v55, v26, v27
    v_exp_f32 v30, v30
    v_exp_f32 v31, v31
    v_cvt_pk_bf16_f32 v56, v28, v29
    v_mfma_f32_32x32x16_bf16 v[84:99], a[12:15], v[64:67], v[84:99]
    s_waitcnt vmcnt(9)
    v_exp_f32 v32, v32
    v_exp_f32 v33, v33
    v_cvt_pk_bf16_f32 v57, v30, v31
    v_exp_f32 v34, v34
    v_exp_f32 v35, v35
    v_cvt_pk_bf16_f32 v58, v32, v33
    v_cvt_pk_bf16_f32 v59, v34, v35
    v_mfma_f32_32x32x16_bf16 v[20:35], a[32:35], v[4:7], 0
    buffer_load_dwordx4 a[8:11], v1, s[4:7], s14 offen offset:0
    v_exp_f32 v36, v36
    v_exp_f32 v37, v37
    v_exp_f32 v38, v38
    v_exp_f32 v39, v39
    v_cvt_pk_bf16_f32 v60, v36, v37
    v_mfma_f32_32x32x16_bf16 v[20:35], a[36:39], v[8:11], v[20:35]
    v_exp_f32 v40, v40
    v_exp_f32 v41, v41
    v_cvt_pk_bf16_f32 v61, v38, v39
    v_exp_f32 v42, v42
    v_exp_f32 v43, v43
    v_cvt_pk_bf16_f32 v62, v40, v41
    v_mfma_f32_32x32x16_bf16 v[68:83], a[24:27], v[52:55], v[68:83]
    buffer_load_dwordx4 a[12:15], v1, s[4:7], s14 offen offset:1024
    v_exp_f32 v44, v44
    v_exp_f32 v45, v45
    v_cvt_pk_bf16_f32 v63, v42, v43
    v_exp_f32 v46, v46
    v_exp_f32 v47, v47
    v_cvt_pk_bf16_f32 v64, v44, v45
    v_mfma_f32_32x32x16_bf16 v[68:83], a[28:31], v[56:59], v[68:83]
    v_exp_f32 v48, v48
    v_exp_f32 v49, v49
    v_cvt_pk_bf16_f32 v65, v46, v47
    v_exp_f32 v50, v50
    v_exp_f32 v51, v51
    v_cvt_pk_bf16_f32 v66, v48, v49
    v_cvt_pk_bf16_f32 v67, v50, v51
    v_mfma_f32_32x32x16_bf16 v[36:51], a[32:35], v[12:15], 0
    buffer_load_dwordx4 a[20:23], v1, s[4:7], s14 offen offset:3072
    v_exp_f32 v20, v20
    v_exp_f32 v21, v21
    v_exp_f32 v22, v22
    v_exp_f32 v23, v23
    v_cvt_pk_bf16_f32 v52, v20, v21
    v_mfma_f32_32x32x16_bf16 v[36:51], a[36:39], v[16:19], v[36:51]
    s_add_u32 s14, s14, 4096
    v_exp_f32 v24, v24
    v_exp_f32 v25, v25
    v_cvt_pk_bf16_f32 v53, v22, v23
    v_exp_f32 v26, v26
    v_exp_f32 v27, v27
    v_cvt_pk_bf16_f32 v54, v24, v25
    v_mfma_f32_32x32x16_bf16 v[84:99], a[24:27], v[60:63], v[84:99]
    buffer_load_dwordx4 a[32:35], v1, s[4:7], s14 offen offset:2048
    v_exp_f32 v28, v28
    v_exp_f32 v29, v29
    v_cvt_pk_bf16_f32 v55, v26, v27
    v_exp_f32 v30, v30
    v_exp_f32 v31, v31
    v_cvt_pk_bf16_f32 v56, v28, v29
    v_mfma_f32_32x32x16_bf16 v[84:99], a[28:31], v[64:67], v[84:99]
    s_waitcnt vmcnt(9)
    v_exp_f32 v32, v32
    v_exp_f32 v33, v33
    v_cvt_pk_bf16_f32 v57, v30, v31
    v_exp_f32 v34, v34
    v_exp_f32 v35, v35
    v_cvt_pk_bf16_f32 v58, v32, v33
    v_cvt_pk_bf16_f32 v59, v34, v35
    v_mfma_f32_32x32x16_bf16 v[20:35], a[48:51], v[4:7], 0
    buffer_load_dwordx4 a[24:27], v1, s[4:7], s14 offen offset:0
    v_exp_f32 v36, v36
    v_exp_f32 v37, v37
    v_exp_f32 v38, v38
    v_exp_f32 v39, v39
    v_cvt_pk_bf16_f32 v60, v36, v37
    v_mfma_f32_32x32x16_bf16 v[20:35], a[52:55], v[8:11], v[20:35]
    v_exp_f32 v40, v40
    v_exp_f32 v41, v41
    v_cvt_pk_bf16_f32 v61, v38, v39
    v_exp_f32 v42, v42
    v_exp_f32 v43, v43
    v_cvt_pk_bf16_f32 v62, v40, v41
    v_mfma_f32_32x32x16_bf16 v[68:83], a[40:43], v[52:55], v[68:83]
    buffer_load_dwordx4 a[28:31], v1, s[4:7], s14 offen offset:1024
    v_exp_f32 v44, v44
    v_exp_f32 v45, v45
    v_cvt_pk_bf16_f32 v63, v42, v43
    v_exp_f32 v46, v46
    v_exp_f32 v47, v47
    v_cvt_pk_bf16_f32 v64, v44, v45
    v_mfma_f32_32x32x16_bf16 v[68:83], a[44:47], v[56:59], v[68:83]
    v_exp_f32 v48, v48
    v_exp_f32 v49, v49
    v_cvt_pk_bf16_f32 v65, v46, v47
    v_exp_f32 v50, v50
    v_exp_f32 v51, v51
    v_cvt_pk_bf16_f32 v66, v48, v49
    v_cvt_pk_bf16_f32 v67, v50, v51
    v_mfma_f32_32x32x16_bf16 v[36:51], a[48:51], v[12:15], 0
    buffer_load_dwordx4 a[36:39], v1, s[4:7], s14 offen offset:3072
    v_exp_f32 v20, v20
    v_exp_f32 v21, v21
    v_exp_f32 v22, v22
    v_exp_f32 v23, v23
    v_cvt_pk_bf16_f32 v52, v20, v21
    v_mfma_f32_32x32x16_bf16 v[36:51], a[52:55], v[16:19], v[36:51]
    s_add_u32 s14, s14, 4096
    v_exp_f32 v24, v24
    v_exp_f32 v25, v25
    v_cvt_pk_bf16_f32 v53, v22, v23
    v_exp_f32 v26, v26
    v_exp_f32 v27, v27
    v_cvt_pk_bf16_f32 v54, v24, v25
    v_mfma_f32_32x32x16_bf16 v[84:99], a[40:43], v[60:63], v[84:99]
    buffer_load_dwordx4 a[48:51], v1, s[4:7], s14 offen offset:2048
    v_exp_f32 v28, v28
    v_exp_f32 v29, v29
    v_cvt_pk_bf16_f32 v55, v26, v27
    v_exp_f32 v30, v30
    v_exp_f32 v31, v31
    v_cvt_pk_bf16_f32 v56, v28, v29
    v_mfma_f32_32x32x16_bf16 v[84:99], a[44:47], v[64:67], v[84:99]
    s_waitcnt vmcnt(9)
    v_exp_f32 v32, v32
    v_exp_f32 v33, v33
    v_cvt_pk_bf16_f32 v57, v30, v31
    v_exp_f32 v34, v34
    v_exp_f32 v35, v35
    v_cvt_pk_bf16_f32 v58, v32, v33
    v_cvt_pk_bf16_f32 v59, v34, v35
    v_mfma_f32_32x32x16_bf16 v[20:35], a[0:3], v[4:7], 0
    buffer_load_dwordx4 a[40:43], v1, s[4:7], s14 offen offset:0
    v_exp_f32 v36, v36
    v_exp_f32 v37, v37
    v_exp_f32 v38, v38
    v_exp_f32 v39, v39
    v_cvt_pk_bf16_f32 v60, v36, v37
    v_mfma_f32_32x32x16_bf16 v[20:35], a[4:7], v[8:11], v[20:35]
    s_sub_u32 s16, s16, 1
    v_exp_f32 v40, v40
    v_exp_f32 v41, v41
    v_cvt_pk_bf16_f32 v61, v38, v39
    v_exp_f32 v42, v42
    v_exp_f32 v43, v43
    v_cvt_pk_bf16_f32 v62, v40, v41
    v_mfma_f32_32x32x16_bf16 v[68:83], a[56:59], v[52:55], v[68:83]
    buffer_load_dwordx4 a[44:47], v1, s[4:7], s14 offen offset:1024
    v_exp_f32 v44, v44
    v_exp_f32 v45, v45
    v_cvt_pk_bf16_f32 v63, v42, v43
    v_exp_f32 v46, v46
    v_exp_f32 v47, v47
    v_cvt_pk_bf16_f32 v64, v44, v45
    v_mfma_f32_32x32x16_bf16 v[68:83], a[60:63], v[56:59], v[68:83]
    v_exp_f32 v48, v48
    v_exp_f32 v49, v49
    v_cvt_pk_bf16_f32 v65, v46, v47
    v_exp_f32 v50, v50
    v_exp_f32 v51, v51
    v_cvt_pk_bf16_f32 v66, v48, v49
    v_cvt_pk_bf16_f32 v67, v50, v51
    s_cmp_lg_u32 s16, 0
    s_cbranch_scc1 L2_loop
    v_mfma_f32_32x32x16_bf16 v[36:51], a[0:3], v[12:15], 0
    buffer_load_dwordx4 a[52:55], v1, s[4:7], s14 offen offset:3072
    v_exp_f32 v20, v20
    v_exp_f32 v21, v21
    v_exp_f32 v22, v22
    v_exp_f32 v23, v23
    v_cvt_pk_bf16_f32 v52, v20, v21
    v_mfma_f32_32x32x16_bf16 v[36:51], a[4:7], v[16:19], v[36:51]
    s_add_u32 s14, s14, 4096
    v_exp_f32 v24, v24
    v_exp_f32 v25, v25
    v_cvt_pk_bf16_f32 v53, v22, v23
    v_exp_f32 v26, v26
    v_exp_f32 v27, v27
    v_cvt_pk_bf16_f32 v54, v24, v25
    v_mfma_f32_32x32x16_bf16 v[84:99], a[56:59], v[60:63], v[84:99]
    v_exp_f32 v28, v28
    v_exp_f32 v29, v29
    v_cvt_pk_bf16_f32 v55, v26, v27
    v_exp_f32 v30, v30
    v_exp_f32 v31, v31
    v_cvt_pk_bf16_f32 v56, v28, v29
    v_mfma_f32_32x32x16_bf16 v[84:99], a[60:63], v[64:67], v[84:99]
    s_waitcnt vmcnt(8)
    v_exp_f32 v32, v32
    v_exp_f32 v33, v33
    v_cvt_pk_bf16_f32 v57, v30, v31
    v_exp_f32 v34, v34
    v_exp_f32 v35, v35
    v_cvt_pk_bf16_f32 v58, v32, v33
    v_cvt_pk_bf16_f32 v59, v34, v35
    v_mfma_f32_32x32x16_bf16 v[20:35], a[16:19], v[4:7], 0
    buffer_load_dwordx4 a[56:59], v1, s[4:7], s14 offen offset:0
    v_exp_f32 v36, v36
    v_exp_f32 v37, v37
    v_exp_f32 v38, v38
    v_exp_f32 v39, v39
    v_cvt_pk_bf16_f32 v60, v36, v37
    v_mfma_f32_32x32x16_bf16 v[20:35], a[20:23], v[8:11], v[20:35]
    v_exp_f32 v40, v40
    v_exp_f32 v41, v41
    v_cvt_pk_bf16_f32 v61, v38, v39
    v_exp_f32 v42, v42
    v_exp_f32 v43, v43
    v_cvt_pk_bf16_f32 v62, v40, v41
    v_mfma_f32_32x32x16_bf16 v[68:83], a[8:11], v[52:55], v[68:83]
    buffer_load_dwordx4 a[60:63], v1, s[4:7], s14 offen offset:1024
    v_exp_f32 v44, v44
    v_exp_f32 v45, v45
    v_cvt_pk_bf16_f32 v63, v42, v43
    v_exp_f32 v46, v46
    v_exp_f32 v47, v47
    v_cvt_pk_bf16_f32 v64, v44, v45
    v_mfma_f32_32x32x16_bf16 v[68:83], a[12:15], v[56:59], v[68:83]
    v_exp_f32 v48, v48
    v_exp_f32 v49, v49
    v_cvt_pk_bf16_f32 v65, v46, v47
    v_exp_f32 v50, v50
    v_exp_f32 v51, v51
    v_cvt_pk_bf16_f32 v66, v48, v49
    v_cvt_pk_bf16_f32 v67, v50, v51
    v_mfma_f32_32x32x16_bf16 v[36:51], a[16:19], v[12:15], 0
    v_exp_f32 v20, v20
    v_exp_f32 v21, v21
    v_exp_f32 v22, v22
    v_exp_f32 v23, v23
    v_cvt_pk_bf16_f32 v52, v20, v21
    v_mfma_f32_32x32x16_bf16 v[36:51], a[20:23], v[16:19], v[36:51]
    v_exp_f32 v24, v24
    v_exp_f32 v25, v25
    v_cvt_pk_bf16_f32 v53, v22, v23
    v_exp_f32 v26, v26
    v_exp_f32 v27, v27
    v_cvt_pk_bf16_f32 v54, v24, v25
    v_mfma_f32_32x32x16_bf16 v[84:99], a[8:11], v[60:63], v[84:99]
    v_exp_f32 v28, v28
    v_exp_f32 v29, v29
    v_cvt_pk_bf16_f32 v55, v26, v27
    v_exp_f32 v30, v30
    v_exp_f32 v31, v31
    v_cvt_pk_bf16_f32 v56, v28, v29
    v_mfma_f32_32x32x16_bf16 v[84:99], a[12:15], v[64:67], v[84:99]
    s_waitcnt vmcnt(6)
    v_exp_f32 v32, v32
    v_exp_f32 v33, v33
    v_cvt_pk_bf16_f32 v57, v30, v31
    v_exp_f32 v34, v34
    v_exp_f32 v35, v35
    v_cvt_pk_bf16_f32 v58, v32, v33
    v_cvt_pk_bf16_f32 v59, v34, v35
    v_mfma_f32_32x32x16_bf16 v[20:35], a[32:35], v[4:7], 0
    v_exp_f32 v36, v36
    v_exp_f32 v37, v37
    v_exp_f32 v38, v38
    v_exp_f32 v39, v39
    v_cvt_pk_bf16_f32 v60, v36, v37
    v_mfma_f32_32x32x16_bf16 v[20:35], a[36:39], v[8:11], v[20:35]
    v_exp_f32 v40, v40
    v_exp_f32 v41, v41
    v_cvt_pk_bf16_f32 v61, v38, v39
    v_exp_f32 v42, v42
    v_exp_f32 v43, v43
    v_cvt_pk_bf16_f32 v62, v40, v41
    v_mfma_f32_32x32x16_bf16 v[68:83], a[24:27], v[52:55], v[68:83]
    v_exp_f32 v44, v44
    v_exp_f32 v45, v45
    v_cvt_pk_bf16_f32 v63, v42, v43
    v_exp_f32 v46, v46
    v_exp_f32 v47, v47
    v_cvt_pk_bf16_f32 v64, v44, v45
    v_mfma_f32_32x32x16_bf16 v[68:83], a[28:31], v[56:59], v[68:83]
    v_exp_f32 v48, v48
    v_exp_f32 v49, v49
    v_cvt_pk_bf16_f32 v65, v46, v47
    v_exp_f32 v50, v50
    v_exp_f32 v51, v51
    v_cvt_pk_bf16_f32 v66, v48, v49
    v_cvt_pk_bf16_f32 v67, v50, v51
    v_mfma_f32_32x32x16_bf16 v[36:51], a[32:35], v[12:15], 0
    v_exp_f32 v20, v20
    v_exp_f32 v21, v21
    v_exp_f32 v22, v22
    v_exp_f32 v23, v23
    v_cvt_pk_bf16_f32 v52, v20, v21
    v_mfma_f32_32x32x16_bf16 v[36:51], a[36:39], v[16:19], v[36:51]
    v_exp_f32 v24, v24
    v_exp_f32 v25, v25
    v_cvt_pk_bf16_f32 v53, v22, v23
    v_exp_f32 v26, v26
    v_exp_f32 v27, v27
    v_cvt_pk_bf16_f32 v54, v24, v25
    v_mfma_f32_32x32x16_bf16 v[84:99], a[24:27], v[60:63], v[84:99]
    v_exp_f32 v28, v28
    v_exp_f32 v29, v29
    v_cvt_pk_bf16_f32 v55, v26, v27
    v_exp_f32 v30, v30
    v_exp_f32 v31, v31
    v_cvt_pk_bf16_f32 v56, v28, v29
    v_mfma_f32_32x32x16_bf16 v[84:99], a[28:31], v[64:67], v[84:99]
    s_waitcnt vmcnt(2)
    v_exp_f32 v32, v32
    v_exp_f32 v33, v33
    v_cvt_pk_bf16_f32 v57, v30, v31
    v_exp_f32 v34, v34
    v_exp_f32 v35, v35
    v_cvt_pk_bf16_f32 v58, v32, v33
    v_cvt_pk_bf16_f32 v59, v34, v35
    v_mfma_f32_32x32x16_bf16 v[20:35], a[48:51], v[4:7], 0
    v_exp_f32 v36, v36
    v_exp_f32 v37, v37
    v_exp_f32 v38, v38
    v_exp_f32 v39, v39
    v_cvt_pk_bf16_f32 v60, v36, v37
    v_mfma_f32_32x32x16_bf16 v[20:35], a[52:55], v[8:11], v[20:35]
    v_exp_f32 v40, v40
    v_exp_f32 v41, v41
    v_cvt_pk_bf16_f32 v61, v38, v39
    v_exp_f32 v42, v42
    v_exp_f32 v43, v43
    v_cvt_pk_bf16_f32 v62, v40, v41
    v_mfma_f32_32x32x16_bf16 v[68:83], a[40:43], v[52:55], v[68:83]
    v_exp_f32 v44, v44
    v_exp_f32 v45, v45
    v_cvt_pk_bf16_f32 v63, v42, v43
    v_exp_f32 v46, v46
    v_exp_f32 v47, v47
    v_cvt_pk_bf16_f32 v64, v44, v45
    v_mfma_f32_32x32x16_bf16 v[68:83], a[44:47], v[56:59], v[68:83]
    v_exp_f32 v48, v48
    v_exp_f32 v49, v49
    v_cvt_pk_bf16_f32 v65, v46, v47
    v_exp_f32 v50, v50
    v_exp_f32 v51, v51
    v_cvt_pk_bf16_f32 v66, v48, v49
    v_cvt_pk_bf16_f32 v67, v50, v51
    v_mfma_f32_32x32x16_bf16 v[36:51], a[48:51], v[12:15], 0
    v_exp_f32 v20, v20
    v_exp_f32 v21, v21
    v_exp_f32 v22, v22
    v_exp_f32 v23, v23
    v_cvt_pk_bf16_f32 v52, v20, v21
    v_mfma_f32_32x32x16_bf16 v[36:51], a[52:55], v[16:19], v[36:51]
    v_exp_f32 v24, v24
    v_exp_f32 v25, v25
    v_cvt_pk_bf16_f32 v53, v22, v23
    v_exp_f32 v26, v26
    v_exp_f32 v27, v27
    v_cvt_pk_bf16_f32 v54, v24, v25
    v_mfma_f32_32x32x16_bf16 v[84:99], a[40:43], v[60:63], v[84:99]
    v_exp_f32 v28, v28
    v_exp_f32 v29, v29
    v_cvt_pk_bf16_f32 v55, v26, v27
    v_exp_f32 v30, v30
    v_exp_f32 v31, v31
    v_cvt_pk_bf16_f32 v56, v28, v29
    v_mfma_f32_32x32x16_bf16 v[84:99], a[44:47], v[64:67], v[84:99]
    s_waitcnt vmcnt(0)
    v_exp_f32 v32, v32
    v_exp_f32 v33, v33
    v_cvt_pk_bf16_f32 v57, v30, v31
    v_exp_f32 v34, v34
    v_exp_f32 v35, v35
    v_cvt_pk_bf16_f32 v58, v32, v33
    v_cvt_pk_bf16_f32 v59, v34, v35
    v_mfma_f32_32x32x16_bf16 v[68:83], a[56:59], v[52:55], v[68:83]
    v_exp_f32 v36, v36
    v_exp_f32 v37, v37
    v_exp_f32 v38, v38
    v_exp_f32 v39, v39
    v_cvt_pk_bf16_f32 v60, v36, v37
    v_mfma_f32_32x32x16_bf16 v[68:83], a[60:63], v[56:59], v[68:83]
    v_exp_f32 v40, v40
    v_exp_f32 v41, v41
    v_cvt_pk_bf16_f32 v61, v38, v39
    v_exp_f32 v42, v42
    v_exp_f32 v43, v43
    v_cvt_pk_bf16_f32 v62, v40, v41
    v_exp_f32 v44, v44
    v_exp_f32 v45, v45
    v_cvt_pk_bf16_f32 v63, v42, v43
    v_exp_f32 v46, v46
    v_exp_f32 v47, v47
    v_cvt_pk_bf16_f32 v64, v44, v45
    ds_write_b128 v3, v[68:71] offset:0
    ds_write_b128 v3, v[72:75] offset:1024
    ds_write_b128 v3, v[76:79] offset:2048
    ds_write_b128 v3, v[80:83] offset:3072
    v_exp_f32 v48, v48
    v_exp_f32 v49, v49
    v_cvt_pk_bf16_f32 v65, v46, v47
    v_exp_f32 v50, v50
    v_exp_f32 v51, v51
    v_cvt_pk_bf16_f32 v66, v48, v49
    v_cvt_pk_bf16_f32 v67, v50, v51
    v_mfma_f32_32x32x16_bf16 v[84:99], a[56:59], v[60:63], v[84:99]
    s_nop 0
    v_mfma_f32_32x32x16_bf16 v[84:99], a[60:63], v[64:67], v[84:99]
    s_waitcnt lgkmcnt(0)
    s_barrier
    ds_read_b128 v[68:71], v2 offset:0
    ds_read_b128 v[72:75], v2 offset:1024
    ds_read_b128 v[76:79], v2 offset:2048
    ds_read_b128 v[80:83], v2 offset:3072
    s_waitcnt lgkmcnt(3)
    s_nop 4
    v_pk_add_f32 v[84:85], v[84:85], v[68:69]
    v_pk_add_f32 v[86:87], v[86:87], v[70:71]
    s_waitcnt lgkmcnt(2)
    v_pk_add_f32 v[88:89], v[88:89], v[72:73]
    v_pk_add_f32 v[90:91], v[90:91], v[74:75]
    s_waitcnt lgkmcnt(1)
    v_pk_add_f32 v[92:93], v[92:93], v[76:77]
    v_pk_add_f32 v[94:95], v[94:95], v[78:79]
    s_waitcnt lgkmcnt(0)
    v_pk_add_f32 v[96:97], v[96:97], v[80:81]
    v_pk_add_f32 v[98:99], v[98:99], v[82:83]
    v_pk_mul_f32 v[100:101], v[84:85], 0
    v_pk_fma_f32 v[100:101], v[86:87], 0, v[100:101]
    v_pk_fma_f32 v[100:101], v[88:89], 0, v[100:101]
    v_pk_fma_f32 v[100:101], v[90:91], 0, v[100:101]
    v_pk_fma_f32 v[100:101], v[92:93], 0, v[100:101]
    v_pk_fma_f32 v[100:101], v[94:95], 0, v[100:101]
    v_pk_fma_f32 v[100:101], v[96:97], 0, v[100:101]
    v_pk_fma_f32 v[100:101], v[98:99], 0, v[100:101]
    v_cmp_u_f32 vcc, v100, v101
    s_cbranch_vccnz L2_slow
L2_norm:
    v_mov_b32 v100, v96
    v_mov_b32 v102, v96
    s_nop 1
    v_permlane32_swap_b32 v100, v102
    v_rcp_f32 v102, v102
    s_nop 0
    v_pk_mul_f32 v[84:85], v[84:85], v[102:103] op_sel_hi:[1,0]
    v_pk_mul_f32 v[86:87], v[86:87], v[102:103] op_sel_hi:[1,0]
    v_pk_mul_f32 v[88:89], v[88:89], v[102:103] op_sel_hi:[1,0]
    v_pk_mul_f32 v[90:91], v[90:91], v[102:103] op_sel_hi:[1,0]
    v_pk_mul_f32 v[92:93], v[92:93], v[102:103] op_sel_hi:[1,0]
    v_pk_mul_f32 v[94:95], v[94:95], v[102:103] op_sel_hi:[1,0]
    v_pk_mul_f32 v[96:97], v[96:97], v[102:103] op_sel_hi:[1,0]
    v_pk_mul_f32 v[98:99], v[98:99], v[102:103] op_sel_hi:[1,0]
    v_cvt_pk_bf16_f32 v52, v84, v85
    v_cvt_pk_bf16_f32 v53, v86, v87
    v_cvt_pk_bf16_f32 v54, v88, v89
    v_cvt_pk_bf16_f32 v55, v90, v91
    v_cvt_pk_bf16_f32 v56, v92, v93
    v_cvt_pk_bf16_f32 v57, v94, v95
    v_cvt_pk_bf16_f32 v58, v96, v97
    v_cvt_pk_bf16_f32 v59, v98, v99
    s_mov_b32 exec_lo, 0
    s_mov_b32 exec_hi, -1
    v_mov_b32 v58, 0
    v_mov_b32 v59, 0
    s_mov_b64 exec, -1
    buffer_store_dwordx4 v[52:55], v1, s[4:7], s19 offen offset:0 sc1
    buffer_store_dwordx4 v[56:59], v1, s[4:7], s19 offen offset:1024 sc1
L2_end:
    s_endpgm
L2_help:
    s_and_b32 s3, s2, 4
    s_lshl_b32 s3, s3, 3
    s_add_u32 s3, s3, 16
    s_load_dwordx2 s[22:23], s[0:1], s3
    s_load_dwordx2 s[34:35], s[0:1], 48
    s_load_dwordx2 s[20:21], s[0:1], 40
    v_mov_b32 v100, 22528
    v_mov_b32 v101, 0
    ds_write_b32 v100, v101
    s_and_b32 s8, s8, 3
    s_add_u32 s11, s11, s8
    s_lshl_b32 s10, s9, 6
    s_add_u32 s10, s11, s10
    s_lshl_b32 s18, s10, 11
    s_add_u32 s18, s18, 0x600000
    s_lshl_b32 s17, s9, 17
    s_lshl_b32 s10, s8, 11
    s_add_u32 s17, s17, s10
    s_lshr_b32 s17, s17, 1
    s_add_u32 s17, s17, 0x800000
    s_mov_b32 s32, 0x3fb8aa3b
    s_mov_b32 s33, 0x3fb8aa3b
    s_lshl_b32 s10, s11, 4
    s_add_u32 s10, s10, s9
    s_lshl_b32 s10, s10, 11
    s_add_u32 s19, s10, 0xc00000
    s_add_u32 s13, s10, 0xa00000
    s_lshl_b32 s10, s8, 10
    v_add_u32 v2, s10, v1
    v_lshrrev_b32 v100, 9, v1
    v_bfe_u32 v101, v1, 6, 2
    v_lshl_add_u32 v100, v100, 2, v101
    v_mul_u32_u24 v100, 56, v100
    v_bfe_u32 v101, v1, 8, 1
    v_lshl_add_u32 v100, v101, 5, v100
    v_bfe_u32 v101, v1, 4, 2
    v_lshl_add_u32 v3, v101, 3, v100
    s_lshr_b32 s10, s2, 3
    s_lshl_b32 s10, s10, 2
    s_add_u32 s10, s10, s8
    s_mul_i32 s3, s10, 3200
    v_lshlrev_b32 v110, 3, v1
    v_mov_b32 v111, 0x40000000
    v_cmp_gt_u32 vcc, 3200, v110
    s_and_b32 s16, s8, 1
    s_lshl_b32 s16, s16, 10
    v_cndmask_b32 v110, v111, v110, vcc
    s_add_u32 m0, s16, 20480
    s_mul_i32 s10, s9, 1568
    s_add_u32 s16, s16, s10
    s_setprio 0
    s_waitcnt lgkmcnt(0)
    s_barrier
    s_mov_b32 s24, s22
    s_mov_b32 s25, s23
    s_mov_b32 s26, 0x62000
    s_mov_b32 s27, 0x00020000
    s_mov_b32 s28, s20
    s_mov_b32 s29, s21
    s_mov_b32 s30, 0x6200
    s_mov_b32 s31, 0x00020000
    buffer_load_dwordx4 v1, s[28:31], s16 offen lds
    buffer_load_dwordx4 a[24:27], v1, s[4:7], s18 offen offset:0
    buffer_load_dwordx4 a[28:31], v1, s[4:7], s18 offen offset:1024
    s_mov_b32 s10, 0xe10000
    buffer_load_dwordx4 a[32:35], v1, s[4:7], s10 offen offset:0
    buffer_load_dwordx4 a[36:39], v1, s[4:7], s17 offen offset:0
    s_add_u32 s17, s17, 4096
    buffer_load_dwordx4 a[40:43], v1, s[4:7], s17 offen offset:0
    s_add_u32 s17, s17, 4096
    v_mov_b32 v96, 0
    v_mov_b32 v124, 0
    v_mov_b32 v97, 0
    v_mov_b32 v125, 0
    v_mov_b32 v98, 0
    v_mov_b32 v126, 0
    v_mov_b32 v99, 0
    v_mov_b32 v127, 0
    buffer_load_dwordx4 a[44:47], v1, s[4:7], s17 offen offset:0
    s_add_u32 s17, s17, 4096
    s_waitcnt vmcnt(2)
    v_mfma_f32_32x32x16_bf16 v[4:19], a[32:35], a[36:39], 0
    buffer_load_dwordx4 a[48:51], v1, s[4:7], s17 offen offset:0
    s_add_u32 s17, s17, 4096
    s_waitcnt vmcnt(2)
    s_setprio 1
    v_mfma_f32_32x32x16_bf16 v[4:19], a[32:35], a[40:43], v[4:19]
    buffer_load_dwordx4 a[52:55], v1, s[4:7], s17 offen offset:0
    s_add_u32 s17, s17, 4096
    s_waitcnt vmcnt(2)
    v_mfma_f32_32x32x16_bf16 v[4:19], a[32:35], a[44:47], v[4:19]
    buffer_load_dwordx4 a[56:59], v1, s[4:7], s17 offen offset:0
    s_add_u32 s17, s17, 4096
    s_waitcnt vmcnt(2)
    v_mfma_f32_32x32x16_bf16 v[4:19], a[32:35], a[48:51], v[4:19]
    buffer_load_dwordx4 a[60:63], v1, s[4:7], s17 offen offset:0
    s_add_u32 s17, s17, 4096
    s_waitcnt vmcnt(2)
    v_mfma_f32_32x32x16_bf16 v[4:19], a[32:35], a[52:55], v[4:19]
    buffer_load_dwordx4 a[64:67], v1, s[4:7], s17 offen offset:0
    s_add_u32 s17, s17, 4096
    s_waitcnt vmcnt(2)
    v_mfma_f32_32x32x16_bf16 v[4:19], a[32:35], a[56:59], v[4:19]
    buffer_load_dwordx4 a[68:71], v1, s[4:7], s17 offen offset:0
    s_add_u32 s17, s17, 4096
    s_waitcnt vmcnt(2)
    v_mfma_f32_32x32x16_bf16 v[4:19], a[32:35], a[60:63], v[4:19]
    buffer_load_dwordx4 a[72:75], v1, s[4:7], s17 offen offset:0
    s_add_u32 s17, s17, 4096
    s_waitcnt vmcnt(2)
    v_mfma_f32_32x32x16_bf16 v[4:19], a[32:35], a[64:67], v[4:19]
    buffer_load_dwordx4 a[76:79], v1, s[4:7], s17 offen offset:0
    s_add_u32 s17, s17, 4096
    s_waitcnt vmcnt(2)
    v_mfma_f32_32x32x16_bf16 v[4:19], a[32:35], a[68:71], v[4:19]
    buffer_load_dwordx4 a[80:83], v1, s[4:7], s17 offen offset:0
    s_add_u32 s17, s17, 4096
    s_waitcnt vmcnt(2)
    v_mfma_f32_32x32x16_bf16 v[4:19], a[32:35], a[72:75], v[4:19]
    buffer_load_dwordx4 a[84:87], v1, s[4:7], s17 offen offset:0
    s_add_u32 s17, s17, 4096
    s_waitcnt vmcnt(2)
    v_mfma_f32_32x32x16_bf16 v[4:19], a[32:35], a[76:79], v[4:19]
    buffer_load_dwordx4 a[88:91], v1, s[4:7], s17 offen offset:0
    s_add_u32 s17, s17, 4096
    s_waitcnt vmcnt(2)
    v_mfma_f32_32x32x16_bf16 v[4:19], a[32:35], a[80:83], v[4:19]
    buffer_load_dwordx4 a[92:95], v1, s[4:7], s17 offen offset:0
    s_add_u32 s17, s17, 4096
    s_waitcnt vmcnt(2)
    v_mfma_f32_32x32x16_bf16 v[4:19], a[32:35], a[84:87], v[4:19]
    buffer_load_dwordx4 a[96:99], v1, s[4:7], s17 offen offset:0
    s_add_u32 s17, s17, 4096
    s_waitcnt vmcnt(2)
    v_mfma_f32_32x32x16_bf16 v[4:19], a[32:35], a[88:91], v[4:19]
    s_waitcnt vmcnt(1)
    v_mfma_f32_32x32x16_bf16 v[4:19], a[32:35], a[92:95], v[4:19]
    s_waitcnt vmcnt(0)
    v_mfma_f32_32x32x16_bf16 v[4:19], a[32:35], a[96:99], v[4:19]
    s_nop 11
    v_cvt_pk_bf16_f32 v100, v4, v5
    v_cvt_pk_bf16_f32 v101, v6, v7
    v_cvt_pk_bf16_f32 v102, v8, v9
    v_cvt_pk_bf16_f32 v103, v10, v11
    s_mov_b32 exec_lo, 0x20000000
    s_mov_b32 exec_hi, 0x20000000
    v_mov_b32 v100, 0x3f803f80
    v_mov_b32 v101, 0x3f803f80
    v_mov_b32 v102, 0x3f803f80
    v_mov_b32 v103, 0x3f803f80
    s_mov_b64 exec, -1
    ds_write_b128 v2, v[100:103] offset:16384
    buffer_load_dword v111, v110, s[24:27], s3 offen
    v_mov_b32 v104, 22528
    v_mov_b32 v105, 1
    s_mov_b64 exec, 1
    s_waitcnt lgkmcnt(0)
    ds_add_u32 v104, v105
L2_poll:
    ds_read_b32 v105, v104
    s_waitcnt lgkmcnt(0)
    v_cmp_ne_u32 vcc, 4, v105
    s_cbranch_vccnz L2_poll
    s_mov_b64 exec, -1
    ds_read_b64_tr_b16 a[16:17], v3 offset:20480
    ds_read_b64_tr_b16 a[18:19], v3 offset:20928
    ds_read_b64_tr_b16 a[20:21], v3 offset:21376
    ds_read_b64_tr_b16 a[22:23], v3 offset:21824
    ds_read_b128 a[0:3], v1 offset:16384
    ds_read_b128 a[4:7], v1 offset:17408
    ds_read_b128 a[8:11], v1 offset:18432
    ds_read_b128 a[12:15], v1 offset:19456
    s_setprio 1
    s_waitcnt lgkmcnt(4)
    v_mfma_f32_32x32x16_bf16 v[44:59], a[16:19], a[24:27], 0
    v_mfma_f32_32x32x16_bf16 v[44:59], a[20:23], a[28:31], v[44:59]
    s_nop 11
    v_max3_f32 v100, v44, v45, v46
    v_max3_f32 v100, v100, v47, v48
    v_max3_f32 v100, v100, v49, v50
    v_max3_f32 v100, v100, v51, v52
    v_max3_f32 v100, v100, v53, v54
    v_max_f32 v100, v100, v55
    v_min3_f32 v102, v44, v45, v46
    v_min3_f32 v102, v102, v47, v48
    v_min3_f32 v102, v102, v49, v50
    v_min3_f32 v102, v102, v51, v52
    v_min3_f32 v102, v102, v53, v54
    v_min_f32 v102, v102, v55
    s_mov_b64 exec, 0xffffffff
    v_max3_f32 v100, v100, v56, v57
    v_max3_f32 v100, v100, v58, v59
    v_min3_f32 v102, v102, v56, v57
    v_min3_f32 v102, v102, v58, v59
    s_mov_b64 exec, -1
    v_mov_b32 v104, v100
    v_mov_b32 v105, v102
    s_nop 0
    v_permlane32_swap_b32 v100, v104
    v_permlane32_swap_b32 v102, v105
    v_max_f32 v100, v100, v104
    v_min_f32 v102, v102, v105
    v_mul_f32 v100, s32, v100
    v_mul_f32 v102, s32, v102
    v_pk_fma_f32 v[84:85], v[44:45], s[32:33], v[100:101] op_sel_hi:[1,1,0] neg_lo:[0,0,1] neg_hi:[0,0,1]
    v_pk_fma_f32 v[112:113], v[44:45], s[32:33], v[102:103] op_sel_hi:[1,1,0] neg_lo:[1,0,0] neg_hi:[1,0,0]
    v_pk_fma_f32 v[86:87], v[46:47], s[32:33], v[100:101] op_sel_hi:[1,1,0] neg_lo:[0,0,1] neg_hi:[0,0,1]
    v_pk_fma_f32 v[114:115], v[46:47], s[32:33], v[102:103] op_sel_hi:[1,1,0] neg_lo:[1,0,0] neg_hi:[1,0,0]
    v_pk_fma_f32 v[88:89], v[48:49], s[32:33], v[100:101] op_sel_hi:[1,1,0] neg_lo:[0,0,1] neg_hi:[0,0,1]
    v_pk_fma_f32 v[116:117], v[48:49], s[32:33], v[102:103] op_sel_hi:[1,1,0] neg_lo:[1,0,0] neg_hi:[1,0,0]
    v_pk_fma_f32 v[90:91], v[50:51], s[32:33], v[100:101] op_sel_hi:[1,1,0] neg_lo:[0,0,1] neg_hi:[0,0,1]
    v_pk_fma_f32 v[118:119], v[50:51], s[32:33], v[102:103] op_sel_hi:[1,1,0] neg_lo:[1,0,0] neg_hi:[1,0,0]
    v_pk_fma_f32 v[92:93], v[52:53], s[32:33], v[100:101] op_sel_hi:[1,1,0] neg_lo:[0,0,1] neg_hi:[0,0,1]
    v_pk_fma_f32 v[120:121], v[52:53], s[32:33], v[102:103] op_sel_hi:[1,1,0] neg_lo:[1,0,0] neg_hi:[1,0,0]
    v_pk_fma_f32 v[94:95], v[54:55], s[32:33], v[100:101] op_sel_hi:[1,1,0] neg_lo:[0,0,1] neg_hi:[0,0,1]
    v_pk_fma_f32 v[122:123], v[54:55], s[32:33], v[102:103] op_sel_hi:[1,1,0] neg_lo:[1,0,0] neg_hi:[1,0,0]
    s_mov_b64 exec, 0xffffffff
    v_pk_fma_f32 v[96:97], v[56:57], s[32:33], v[100:101] op_sel_hi:[1,1,0] neg_lo:[0,0,1] neg_hi:[0,0,1]
    v_pk_fma_f32 v[124:125], v[56:57], s[32:33], v[102:103] op_sel_hi:[1,1,0] neg_lo:[1,0,0] neg_hi:[1,0,0]
    v_pk_fma_f32 v[98:99], v[58:59], s[32:33], v[100:101] op_sel_hi:[1,1,0] neg_lo:[0,0,1] neg_hi:[0,0,1]
    v_pk_fma_f32 v[126:127], v[58:59], s[32:33], v[102:103] op_sel_hi:[1,1,0] neg_lo:[1,0,0] neg_hi:[1,0,0]
    v_exp_f32 v96, v96
    v_exp_f32 v124, v124
    v_exp_f32 v97, v97
    v_exp_f32 v125, v125
    v_exp_f32 v98, v98
    v_exp_f32 v126, v126
    v_exp_f32 v99, v99
    v_exp_f32 v127, v127
    s_mov_b64 exec, -1
    v_exp_f32 v84, v84
    v_exp_f32 v112, v112
    v_exp_f32 v85, v85
    v_exp_f32 v113, v113
    v_exp_f32 v86, v86
    v_exp_f32 v114, v114
    v_exp_f32 v87, v87
    v_exp_f32 v115, v115
    v_exp_f32 v88, v88
    v_exp_f32 v116, v116
    v_exp_f32 v89, v89
    v_exp_f32 v117, v117
    v_exp_f32 v90, v90
    v_exp_f32 v118, v118
    v_exp_f32 v91, v91
    v_exp_f32 v119, v119
    v_exp_f32 v92, v92
    v_exp_f32 v120, v120
    v_exp_f32 v93, v93
    v_exp_f32 v121, v121
    v_exp_f32 v94, v94
    v_exp_f32 v122, v122
    v_exp_f32 v95, v95
    v_exp_f32 v123, v123
    v_cvt_pk_bf16_f32 v60, v84, v85
    v_cvt_pk_bf16_f32 v61, v86, v87
    v_cvt_pk_bf16_f32 v62, v88, v89
    v_cvt_pk_bf16_f32 v63, v90, v91
    v_cvt_pk_bf16_f32 v64, v92, v93
    v_cvt_pk_bf16_f32 v65, v94, v95
    v_cvt_pk_bf16_f32 v66, v96, v97
    v_cvt_pk_bf16_f32 v67, v98, v99
    v_cvt_pk_bf16_f32 v68, v112, v113
    v_cvt_pk_bf16_f32 v69, v114, v115
    v_cvt_pk_bf16_f32 v70, v116, v117
    v_cvt_pk_bf16_f32 v71, v118, v119
    v_cvt_pk_bf16_f32 v72, v120, v121
    v_cvt_pk_bf16_f32 v73, v122, v123
    v_cvt_pk_bf16_f32 v74, v124, v125
    v_cvt_pk_bf16_f32 v75, v126, v127
    s_waitcnt lgkmcnt(0)
    v_mfma_f32_32x32x16_bf16 v[12:27], a[0:3], v[60:63], 0
    v_mfma_f32_32x32x16_bf16 v[12:27], a[4:7], v[64:67], v[12:27]
    v_mfma_f32_32x32x16_bf16 v[28:43], a[8:11], v[68:71], 0
    v_mfma_f32_32x32x16_bf16 v[28:43], a[12:15], v[72:75], v[28:43]
    s_nop 9
    v_mov_b32 v100, v25
    v_mov_b32 v102, v25
    s_nop 1
    v_permlane32_swap_b32 v100, v102
    v_mov_b32 v101, v41
    v_mov_b32 v104, v41
    s_nop 1
    v_permlane32_swap_b32 v101, v104
    v_rcp_f32 v102, v102
    v_rcp_f32 v104, v104
    v_pk_mul_f32 v[12:13], v[12:13], v[102:103] op_sel_hi:[1,0]
    v_pk_mul_f32 v[14:15], v[14:15], v[102:103] op_sel_hi:[1,0]
    v_pk_mul_f32 v[16:17], v[16:17], v[102:103] op_sel_hi:[1,0]
    v_pk_mul_f32 v[18:19], v[18:19], v[102:103] op_sel_hi:[1,0]
    v_pk_mul_f32 v[20:21], v[20:21], v[102:103] op_sel_hi:[1,0]
    v_pk_mul_f32 v[22:23], v[22:23], v[102:103] op_sel_hi:[1,0]
    v_pk_mul_f32 v[24:25], v[24:25], v[102:103] op_sel_hi:[1,0]
    v_pk_mul_f32 v[26:27], v[26:27], v[102:103] op_sel_hi:[1,0]
    v_pk_fma_f32 v[12:13], v[28:29], v[104:105], v[12:13] op_sel_hi:[1,0,1]
    v_pk_fma_f32 v[14:15], v[30:31], v[104:105], v[14:15] op_sel_hi:[1,0,1]
    v_pk_fma_f32 v[16:17], v[32:33], v[104:105], v[16:17] op_sel_hi:[1,0,1]
    v_pk_fma_f32 v[18:19], v[34:35], v[104:105], v[18:19] op_sel_hi:[1,0,1]
    v_pk_fma_f32 v[20:21], v[36:37], v[104:105], v[20:21] op_sel_hi:[1,0,1]
    v_pk_fma_f32 v[22:23], v[38:39], v[104:105], v[22:23] op_sel_hi:[1,0,1]
    v_pk_fma_f32 v[24:25], v[40:41], v[104:105], v[24:25] op_sel_hi:[1,0,1]
    v_pk_fma_f32 v[26:27], v[42:43], v[104:105], v[26:27] op_sel_hi:[1,0,1]
    v_mov_b32 v100, v24
    v_mov_b32 v102, v24
    s_nop 1
    v_permlane32_swap_b32 v100, v102
    v_add_f32 v102, 0x358637bd, v102
    v_rcp_f32 v102, v102
    s_nop 0
    v_pk_mul_f32 v[12:13], v[12:13], v[102:103] op_sel_hi:[1,0]
    v_pk_mul_f32 v[14:15], v[14:15], v[102:103] op_sel_hi:[1,0]
    v_pk_mul_f32 v[16:17], v[16:17], v[102:103] op_sel_hi:[1,0]
    v_pk_mul_f32 v[18:19], v[18:19], v[102:103] op_sel_hi:[1,0]
    v_pk_mul_f32 v[20:21], v[20:21], v[102:103] op_sel_hi:[1,0]
    v_pk_mul_f32 v[22:23], v[22:23], v[102:103] op_sel_hi:[1,0]
    v_pk_mul_f32 v[24:25], v[24:25], v[102:103] op_sel_hi:[1,0]
    v_pk_mul_f32 v[26:27], v[26:27], v[102:103] op_sel_hi:[1,0]
    v_cvt_pk_bf16_f32 v76, v12, v13
    v_cvt_pk_bf16_f32 v77, v14, v15
    v_cvt_pk_bf16_f32 v78, v16, v17
    v_cvt_pk_bf16_f32 v79, v18, v19
    v_cvt_pk_bf16_f32 v80, v20, v21
    v_cvt_pk_bf16_f32 v81, v22, v23
    v_cvt_pk_bf16_f32 v82, v24, v25
    v_cvt_pk_bf16_f32 v83, v26, v27
    s_mov_b32 exec_lo, 0
    s_mov_b32 exec_hi, -1
    v_mov_b32 v82, 0
    v_mov_b32 v83, 0
    s_mov_b64 exec, -1
    buffer_store_dwordx4 v[76:79], v1, s[4:7], s19 offen offset:0 sc1
    buffer_store_dwordx4 v[80:83], v1, s[4:7], s19 offen offset:1024 sc1
    s_endpgm
L2_slow:
    s_mov_b32 exec_lo, 0
    s_mov_b32 exec_hi, -1
    v_mov_b32 v18, 0
    v_mov_b32 v19, 0
    s_mov_b64 exec, -1
    v_mov_b32 v100, 0xff800000
    s_mov_b32 s14, s13
    s_add_u32 s10, s13, 0x40000
L2_slow1:
    buffer_load_dwordx4 a[0:3], v1, s[4:7], s14 offen offset:0
    buffer_load_dwordx4 a[4:7], v1, s[4:7], s14 offen offset:1024
    s_waitcnt vmcnt(0)
    v_mfma_f32_32x32x16_bf16 v[36:51], a[0:3], v[12:15], 0
    v_mfma_f32_32x32x16_bf16 v[36:51], a[4:7], v[16:19], v[36:51]
    s_nop 11
    v_max3_f32 v100, v100, v36, v37
    v_max3_f32 v100, v100, v38, v39
    v_max3_f32 v100, v100, v40, v41
    v_max3_f32 v100, v100, v42, v43
    v_max3_f32 v100, v100, v44, v45
    v_max3_f32 v100, v100, v46, v47
    v_max3_f32 v100, v100, v48, v49
    v_max3_f32 v100, v100, v50, v51
    s_add_u32 s14, s14, 4096
    s_cmp_lt_u32 s14, s10
    s_cbranch_scc1 L2_slow1
    v_mov_b32 v101, v100
    s_nop 1
    v_permlane32_swap_b32 v100, v101
    v_max_f32 v100, v100, v101
    v_and_b32 v101, s15, v100
    v_sub_f32 v100, v100, v101
    v_and_b32 v102, s15, v100
    v_sub_f32 v100, v100, v102
    s_mov_b32 exec_lo, 0
    s_mov_b32 exec_hi, -1
    v_cvt_pk_bf16_f32 v18, -v101, -v102
    v_cvt_pk_bf16_f32 v19, -v100, 0
    s_mov_b64 exec, -1
    v_mov_b32 v84, 0
    v_mov_b32 v85, 0
    v_mov_b32 v86, 0
    v_mov_b32 v87, 0
    v_mov_b32 v88, 0
    v_mov_b32 v89, 0
    v_mov_b32 v90, 0
    v_mov_b32 v91, 0
    v_mov_b32 v92, 0
    v_mov_b32 v93, 0
    v_mov_b32 v94, 0
    v_mov_b32 v95, 0
    v_mov_b32 v96, 0
    v_mov_b32 v97, 0
    v_mov_b32 v98, 0
    v_mov_b32 v99, 0
    s_mov_b32 s14, s13
L2_slow2:
    buffer_load_dwordx4 a[0:3], v1, s[4:7], s14 offen offset:0
    buffer_load_dwordx4 a[4:7], v1, s[4:7], s14 offen offset:1024
    buffer_load_dwordx4 a[8:11], v1, s[4:7], s14 offen offset:2048
    buffer_load_dwordx4 a[12:15], v1, s[4:7], s14 offen offset:3072
    s_waitcnt vmcnt(0)
    v_mfma_f32_32x32x16_bf16 v[36:51], a[0:3], v[12:15], 0
    v_mfma_f32_32x32x16_bf16 v[36:51], a[4:7], v[16:19], v[36:51]
    s_nop 11
    v_exp_f32 v36, v36
    v_exp_f32 v37, v37
    v_exp_f32 v38, v38
    v_exp_f32 v39, v39
    v_exp_f32 v40, v40
    v_exp_f32 v41, v41
    v_exp_f32 v42, v42
    v_exp_f32 v43, v43
    v_exp_f32 v44, v44
    v_exp_f32 v45, v45
    v_exp_f32 v46, v46
    v_exp_f32 v47, v47
    v_exp_f32 v48, v48
    v_exp_f32 v49, v49
    v_exp_f32 v50, v50
    v_exp_f32 v51, v51
    v_cvt_pk_bf16_f32 v52, v36, v37
    v_cvt_pk_bf16_f32 v53, v38, v39
    v_cvt_pk_bf16_f32 v54, v40, v41
    v_cvt_pk_bf16_f32 v55, v42, v43
    v_cvt_pk_bf16_f32 v56, v44, v45
    v_cvt_pk_bf16_f32 v57, v46, v47
    v_cvt_pk_bf16_f32 v58, v48, v49
    v_cvt_pk_bf16_f32 v59, v50, v51
    v_mfma_f32_32x32x16_bf16 v[84:99], a[8:11], v[52:55], v[84:99]
    s_nop 0
    v_mfma_f32_32x32x16_bf16 v[84:99], a[12:15], v[56:59], v[84:99]
    s_add_u32 s14, s14, 4096
    s_cmp_lt_u32 s14, s10
    s_cbranch_scc1 L2_slow2
    s_nop 7
    s_nop 7
    s_branch L2_norm
.globl oproj_kernel
.p2align 12
.type oproj_kernel,@function
oproj_kernel:
    s_cmp_ge_u32 s2, 224
    s_cbranch_scc1 L3_end
    s_and_b32 s3, s2, 7
    s_lshr_b32 s21, s3, 2
    s_lshl_b32 s24, s21, 5
    s_add_u32 s24, s24, 16
    s_load_dwordx2 s[4:5], s[0:1], s24
    s_load_dwordx2 s[6:7], s[0:1], 72
    s_load_dwordx2 s[0:1], s[0:1], 56
    v_lshrrev_b32 v2, 6, v0
    v_and_b32 v1, 63, v0
    v_readfirstlane_b32 s20, v2
    v_lshlrev_b32 v2, 4, v1
    v_lshrrev_b32 v80, 3, v1
    v_mul_u32_u24 v80, 896, v80
    v_and_b32 v81, 7, v1
    v_bfe_u32 v82, v1, 4, 1
    v_lshlrev_b32 v82, 2, v82
    v_xor_b32 v81, v81, v82
    v_lshl_add_u32 v3, v81, 4, v80
    s_and_b32 s22, s3, 3
    s_lshl_b32 s22, s22, 2
    s_bfe_u32 s24, s2, 0x20003
    s_add_u32 s22, s22, s24
    s_lshr_b32 s23, s2, 5
    s_mul_i32 s25, s20, 7168
    s_lshl_b32 s27, s20, 10
    s_lshl_b32 s24, s23, 7
    s_add_u32 s25, s25, s24
    s_lshl_b32 s26, s21, 6
    s_lshl_b32 s22, s22, 2
    s_add_u32 s22, s22, s20
    s_add_u32 s26, s26, s22
    s_lshl_b32 s26, s26, 15
    s_add_u32 s26, s26, 0xa00000
    s_waitcnt lgkmcnt(0)
    s_mov_b32 s8, s4
    s_mov_b32 s9, s5
    s_mov_b32 s10, 0x62000
    s_mov_b32 s11, 0x00020000
    s_mov_b32 s12, s6
    s_mov_b32 s13, s7
    s_mov_b32 s14, 0xf00000
    s_mov_b32 s15, 0x00020000
    s_add_u32 m0, s27, 0
    s_add_u32 s24, s25, 0
    buffer_load_dwordx4 v3, s[8:11], s24 offen lds
    s_add_u32 s28, s26, 0
    buffer_load_dwordx4 a[0:3], v2, s[12:15], s28 offen offset:0
    buffer_load_dwordx4 a[4:7], v2, s[12:15], s28 offen offset:1024
    s_add_u32 m0, s27, 4096
    s_add_u32 s24, s25, 28672
    buffer_load_dwordx4 v3, s[8:11], s24 offen lds
    buffer_load_dwordx4 a[8:11], v2, s[12:15], s28 offen offset:2048
    buffer_load_dwordx4 a[12:15], v2, s[12:15], s28 offen offset:3072
    s_add_u32 m0, s27, 8192
    s_add_u32 s24, s25, 57344
    buffer_load_dwordx4 v3, s[8:11], s24 offen lds
    s_add_u32 s28, s26, 4096
    buffer_load_dwordx4 a[16:19], v2, s[12:15], s28 offen offset:0
    buffer_load_dwordx4 a[20:23], v2, s[12:15], s28 offen offset:1024
    s_add_u32 m0, s27, 12288
    s_add_u32 s24, s25, 86016
    buffer_load_dwordx4 v3, s[8:11], s24 offen lds
    buffer_load_dwordx4 a[24:27], v2, s[12:15], s28 offen offset:2048
    buffer_load_dwordx4 a[28:31], v2, s[12:15], s28 offen offset:3072
    s_add_u32 m0, s27, 16384
    s_add_u32 s24, s25, 114688
    buffer_load_dwordx4 v3, s[8:11], s24 offen lds
    s_add_u32 s28, s26, 8192
    buffer_load_dwordx4 a[32:35], v2, s[12:15], s28 offen offset:0
    buffer_load_dwordx4 a[36:39], v2, s[12:15], s28 offen offset:1024
    s_add_u32 m0, s27, 20480
    s_add_u32 s24, s25, 143360
    buffer_load_dwordx4 v3, s[8:11], s24 offen lds
    buffer_load_dwordx4 a[40:43], v2, s[12:15], s28 offen offset:2048
    buffer_load_dwordx4 a[44:47], v2, s[12:15], s28 offen offset:3072
    s_mov_b32 s16, s0
    s_mov_b32 s17, s1
    s_mov_b32 s18, 0x380000
    s_mov_b32 s19, 0x00020000
    v_lshrrev_b32 v80, 5, v1
    v_lshlrev_b32 v4, 9, v80
    v_bfe_u32 v81, v1, 2, 2
    v_lshl_add_u32 v4, v81, 7, v4
    v_bfe_u32 v81, v1, 3, 1
    v_lshl_add_u32 v4, v81, 6, v4
    v_bfe_u32 v81, v1, 4, 1
    v_lshl_add_u32 v4, v81, 5, v4
    v_and_b32 v81, 3, v1
    v_lshl_add_u32 v4, v81, 3, v4
    v_xor_b32 v5, 64, v4
    v_and_b32 v81, 31, v1
    v_mul_u32_u24 v81, 1792, v81
    v_lshl_add_u32 v6, v80, 4, v81
    s_mul_i32 s22, s22, 57344
    s_mul_i32 s24, s21, 896
    s_add_u32 s22, s22, s24
    s_lshl_b32 s24, s23, 7
    s_add_u32 s22, s22, s24
    s_lshl_b32 s24, s20, 12
    s_add_u32 s24, s24, 61440
    v_and_b32 v81, 31, v1
    v_lshlrev_b32 v82, 7, v81
    v_add_u32 v82, s24, v82
    v_and_b32 v81, 7, v1
    v_xor_b32 v81, v81, v80
    v_lshl_add_u32 v8, v81, 4, v82
    v_xor_b32 v9, 32, v8
    v_xor_b32 v10, 64, v8
    v_xor_b32 v11, 96, v8
    v_lshrrev_b32 v82, 3, v1
    v_and_b32 v81, 7, v1
    v_mul_u32_u24 v6, 1792, v82
    v_lshl_add_u32 v6, v81, 4, v6
    v_xor_b32 v81, v81, v82
    v_lshlrev_b32 v82, 7, v82
    v_lshl_add_u32 v12, v81, 4, v82
    v_add_u32 v12, s24, v12
    s_waitcnt vmcnt(17)
    s_barrier
    ds_read_b64_tr_b16 v[48:49], v4 offset:0
    ds_read_b64_tr_b16 v[50:51], v4 offset:1024
    ds_read_b64_tr_b16 v[56:57], v5 offset:0
    ds_read_b64_tr_b16 v[58:59], v5 offset:1024
    ds_read_b64_tr_b16 v[52:53], v4 offset:2048
    ds_read_b64_tr_b16 v[54:55], v4 offset:3072
    ds_read_b64_tr_b16 v[60:61], v5 offset:2048
    ds_read_b64_tr_b16 v[62:63], v5 offset:3072
    s_waitcnt vmcnt(14)
    s_barrier
    ds_read_b64_tr_b16 v[64:65], v4 offset:3584
    ds_read_b64_tr_b16 v[66:67], v4 offset:4608
    ds_read_b64_tr_b16 v[72:73], v5 offset:3584
    ds_read_b64_tr_b16 v[74:75], v5 offset:4608
    ds_read_b64_tr_b16 v[68:69], v4 offset:5632
    ds_read_b64_tr_b16 v[70:71], v4 offset:6656
    ds_read_b64_tr_b16 v[76:77], v5 offset:5632
    ds_read_b64_tr_b16 v[78:79], v5 offset:6656
    s_waitcnt vmcnt(15)
    s_waitcnt lgkmcnt(8)
    v_mfma_f32_32x32x16_bf16 v[16:31], v[48:51], a[0:3], 0
    s_add_u32 m0, s27, 24576
    s_add_u32 s24, s25, 172032
    buffer_load_dwordx4 v3, s[8:11], s24 offen lds
    v_mfma_f32_32x32x16_bf16 v[32:47], v[56:59], a[0:3], 0
    s_add_u32 s28, s26, 12288
    buffer_load_dwordx4 a[48:51], v2, s[12:15], s28 offen offset:0
    v_mfma_f32_32x32x16_bf16 v[16:31], v[52:55], a[4:7], v[16:31]
    buffer_load_dwordx4 a[52:55], v2, s[12:15], s28 offen offset:1024
    v_mfma_f32_32x32x16_bf16 v[32:47], v[60:63], a[4:7], v[32:47]
    s_waitcnt vmcnt(14)
    s_barrier
    ds_read_b64_tr_b16 v[48:49], v4 offset:7168
    ds_read_b64_tr_b16 v[50:51], v4 offset:8192
    ds_read_b64_tr_b16 v[56:57], v5 offset:7168
    ds_read_b64_tr_b16 v[58:59], v5 offset:8192
    ds_read_b64_tr_b16 v[52:53], v4 offset:9216
    ds_read_b64_tr_b16 v[54:55], v4 offset:10240
    ds_read_b64_tr_b16 v[60:61], v5 offset:9216
    ds_read_b64_tr_b16 v[62:63], v5 offset:10240
    s_waitcnt vmcnt(15)
    s_waitcnt lgkmcnt(8)
    v_mfma_f32_32x32x16_bf16 v[16:31], v[64:67], a[8:11], v[16:31]
    s_add_u32 m0, s27, 28672
    s_add_u32 s24, s25, 200704
    buffer_load_dwordx4 v3, s[8:11], s24 offen lds
    v_mfma_f32_32x32x16_bf16 v[32:47], v[72:75], a[8:11], v[32:47]
    buffer_load_dwordx4 a[56:59], v2, s[12:15], s28 offen offset:2048
    v_mfma_f32_32x32x16_bf16 v[16:31], v[68:71], a[12:15], v[16:31]
    buffer_load_dwordx4 a[60:63], v2, s[12:15], s28 offen offset:3072
    v_mfma_f32_32x32x16_bf16 v[32:47], v[76:79], a[12:15], v[32:47]
    s_waitcnt vmcnt(14)
    s_barrier
    ds_read_b64_tr_b16 v[64:65], v4 offset:10752
    ds_read_b64_tr_b16 v[66:67], v4 offset:11776
    ds_read_b64_tr_b16 v[72:73], v5 offset:10752
    ds_read_b64_tr_b16 v[74:75], v5 offset:11776
    ds_read_b64_tr_b16 v[68:69], v4 offset:12800
    ds_read_b64_tr_b16 v[70:71], v4 offset:13824
    ds_read_b64_tr_b16 v[76:77], v5 offset:12800
    ds_read_b64_tr_b16 v[78:79], v5 offset:13824
    s_waitcnt vmcnt(15)
    s_waitcnt lgkmcnt(8)
    v_mfma_f32_32x32x16_bf16 v[16:31], v[48:51], a[16:19], v[16:31]
    s_add_u32 s28, s26, 16384
    buffer_load_dwordx4 a[64:67], v2, s[12:15], s28 offen offset:0
    v_mfma_f32_32x32x16_bf16 v[32:47], v[56:59], a[16:19], v[32:47]
    buffer_load_dwordx4 a[68:71], v2, s[12:15], s28 offen offset:1024
    v_mfma_f32_32x32x16_bf16 v[16:31], v[52:55], a[20:23], v[16:31]
    v_mfma_f32_32x32x16_bf16 v[32:47], v[60:63], a[20:23], v[32:47]
    s_waitcnt vmcnt(13)
    s_barrier
    ds_read_b64_tr_b16 v[48:49], v4 offset:14336
    ds_read_b64_tr_b16 v[50:51], v4 offset:15360
    ds_read_b64_tr_b16 v[56:57], v5 offset:14336
    ds_read_b64_tr_b16 v[58:59], v5 offset:15360
    ds_read_b64_tr_b16 v[52:53], v4 offset:16384
    ds_read_b64_tr_b16 v[54:55], v4 offset:17408
    ds_read_b64_tr_b16 v[60:61], v5 offset:16384
    ds_read_b64_tr_b16 v[62:63], v5 offset:17408
    s_waitcnt vmcnt(14)
    s_waitcnt lgkmcnt(8)
    v_mfma_f32_32x32x16_bf16 v[16:31], v[64:67], a[24:27], v[16:31]
    s_add_u32 m0, s27, 32768
    s_add_u32 s24, s25, 229376
    buffer_load_dwordx4 v3, s[8:11], s24 offen lds
    v_mfma_f32_32x32x16_bf16 v[32:47], v[72:75], a[24:27], v[32:47]
    buffer_load_dwordx4 a[72:75], v2, s[12:15], s28 offen offset:2048
    v_mfma_f32_32x32x16_bf16 v[16:31], v[68:71], a[28:31], v[16:31]
    buffer_load_dwordx4 a[76:79], v2, s[12:15], s28 offen offset:3072
    v_mfma_f32_32x32x16_bf16 v[32:47], v[76:79], a[28:31], v[32:47]
    s_waitcnt vmcnt(13)
    s_barrier
    ds_read_b64_tr_b16 v[64:65], v4 offset:17920
    ds_read_b64_tr_b16 v[66:67], v4 offset:18944
    ds_read_b64_tr_b16 v[72:73], v5 offset:17920
    ds_read_b64_tr_b16 v[74:75], v5 offset:18944
    ds_read_b64_tr_b16 v[68:69], v4 offset:19968
    ds_read_b64_tr_b16 v[70:71], v4 offset:20992
    ds_read_b64_tr_b16 v[76:77], v5 offset:19968
    ds_read_b64_tr_b16 v[78:79], v5 offset:20992
    s_waitcnt vmcnt(14)
    s_waitcnt lgkmcnt(8)
    v_mfma_f32_32x32x16_bf16 v[16:31], v[48:51], a[32:35], v[16:31]
    s_add_u32 m0, s27, 36864
    s_add_u32 s24, s25, 258048
    buffer_load_dwordx4 v3, s[8:11], s24 offen lds
    v_mfma_f32_32x32x16_bf16 v[32:47], v[56:59], a[32:35], v[32:47]
    s_add_u32 s28, s26, 20480
    buffer_load_dwordx4 a[80:83], v2, s[12:15], s28 offen offset:0
    v_mfma_f32_32x32x16_bf16 v[16:31], v[52:55], a[36:39], v[16:31]
    buffer_load_dwordx4 a[84:87], v2, s[12:15], s28 offen offset:1024
    v_mfma_f32_32x32x16_bf16 v[32:47], v[60:63], a[36:39], v[32:47]
    s_waitcnt vmcnt(13)
    s_barrier
    ds_read_b64_tr_b16 v[48:49], v4 offset:21504
    ds_read_b64_tr_b16 v[50:51], v4 offset:22528
    ds_read_b64_tr_b16 v[56:57], v5 offset:21504
    ds_read_b64_tr_b16 v[58:59], v5 offset:22528
    ds_read_b64_tr_b16 v[52:53], v4 offset:23552
    ds_read_b64_tr_b16 v[54:55], v4 offset:24576
    ds_read_b64_tr_b16 v[60:61], v5 offset:23552
    ds_read_b64_tr_b16 v[62:63], v5 offset:24576
    s_waitcnt vmcnt(14)
    s_waitcnt lgkmcnt(8)
    v_mfma_f32_32x32x16_bf16 v[16:31], v[64:67], a[40:43], v[16:31]
    s_add_u32 m0, s27, 40960
    s_add_u32 s24, s25, 286720
    buffer_load_dwordx4 v3, s[8:11], s24 offen lds
    v_mfma_f32_32x32x16_bf16 v[32:47], v[72:75], a[40:43], v[32:47]
    buffer_load_dwordx4 a[88:91], v2, s[12:15], s28 offen offset:2048
    v_mfma_f32_32x32x16_bf16 v[16:31], v[68:71], a[44:47], v[16:31]
    buffer_load_dwordx4 a[92:95], v2, s[12:15], s28 offen offset:3072
    v_mfma_f32_32x32x16_bf16 v[32:47], v[76:79], a[44:47], v[32:47]
    s_waitcnt vmcnt(13)
    s_barrier
    ds_read_b64_tr_b16 v[64:65], v4 offset:25088
    ds_read_b64_tr_b16 v[66:67], v4 offset:26112
    ds_read_b64_tr_b16 v[72:73], v5 offset:25088
    ds_read_b64_tr_b16 v[74:75], v5 offset:26112
    ds_read_b64_tr_b16 v[68:69], v4 offset:27136
    ds_read_b64_tr_b16 v[70:71], v4 offset:28160
    ds_read_b64_tr_b16 v[76:77], v5 offset:27136
    ds_read_b64_tr_b16 v[78:79], v5 offset:28160
    s_waitcnt vmcnt(14)
    s_waitcnt lgkmcnt(8)
    v_mfma_f32_32x32x16_bf16 v[16:31], v[48:51], a[48:51], v[16:31]
    s_add_u32 m0, s27, 45056
    s_add_u32 s24, s25, 315392
    buffer_load_dwordx4 v3, s[8:11], s24 offen lds
    v_mfma_f32_32x32x16_bf16 v[32:47], v[56:59], a[48:51], v[32:47]
    s_add_u32 s28, s26, 24576
    buffer_load_dwordx4 a[96:99], v2, s[12:15], s28 offen offset:0
    v_mfma_f32_32x32x16_bf16 v[16:31], v[52:55], a[52:55], v[16:31]
    buffer_load_dwordx4 a[100:103], v2, s[12:15], s28 offen offset:1024
    v_mfma_f32_32x32x16_bf16 v[32:47], v[60:63], a[52:55], v[32:47]
    s_waitcnt vmcnt(16)
    s_barrier
    ds_read_b64_tr_b16 v[48:49], v4 offset:28672
    ds_read_b64_tr_b16 v[50:51], v4 offset:29696
    ds_read_b64_tr_b16 v[56:57], v5 offset:28672
    ds_read_b64_tr_b16 v[58:59], v5 offset:29696
    ds_read_b64_tr_b16 v[52:53], v4 offset:30720
    ds_read_b64_tr_b16 v[54:55], v4 offset:31744
    ds_read_b64_tr_b16 v[60:61], v5 offset:30720
    ds_read_b64_tr_b16 v[62:63], v5 offset:31744
    s_waitcnt vmcnt(14)
    s_waitcnt lgkmcnt(8)
    v_mfma_f32_32x32x16_bf16 v[16:31], v[64:67], a[56:59], v[16:31]
    s_add_u32 m0, s27, 49152
    s_add_u32 s24, s25, 344064
    buffer_load_dwordx4 v3, s[8:11], s24 offen lds
    v_mfma_f32_32x32x16_bf16 v[32:47], v[72:75], a[56:59], v[32:47]
    buffer_load_dwordx4 a[104:107], v2, s[12:15], s28 offen offset:2048
    v_mfma_f32_32x32x16_bf16 v[16:31], v[68:71], a[60:63], v[16:31]
    buffer_load_dwordx4 a[108:111], v2, s[12:15], s28 offen offset:3072
    v_mfma_f32_32x32x16_bf16 v[32:47], v[76:79], a[60:63], v[32:47]
    s_waitcnt vmcnt(14)
    s_barrier
    ds_read_b64_tr_b16 v[64:65], v4 offset:32256
    ds_read_b64_tr_b16 v[66:67], v4 offset:33280
    ds_read_b64_tr_b16 v[72:73], v5 offset:32256
    ds_read_b64_tr_b16 v[74:75], v5 offset:33280
    ds_read_b64_tr_b16 v[68:69], v4 offset:34304
    ds_read_b64_tr_b16 v[70:71], v4 offset:35328
    ds_read_b64_tr_b16 v[76:77], v5 offset:34304
    ds_read_b64_tr_b16 v[78:79], v5 offset:35328
    s_waitcnt vmcnt(15)
    s_waitcnt lgkmcnt(8)
    v_mfma_f32_32x32x16_bf16 v[16:31], v[48:51], a[64:67], v[16:31]
    s_add_u32 m0, s27, 53248
    s_add_u32 s24, s25, 372736
    buffer_load_dwordx4 v3, s[8:11], s24 offen lds
    v_mfma_f32_32x32x16_bf16 v[32:47], v[56:59], a[64:67], v[32:47]
    s_add_u32 s28, s26, 28672
    buffer_load_dwordx4 a[112:115], v2, s[12:15], s28 offen offset:0
    v_mfma_f32_32x32x16_bf16 v[16:31], v[52:55], a[68:71], v[16:31]
    buffer_load_dwordx4 a[116:119], v2, s[12:15], s28 offen offset:1024
    v_mfma_f32_32x32x16_bf16 v[32:47], v[60:63], a[68:71], v[32:47]
    s_waitcnt vmcnt(14)
    s_barrier
    ds_read_b64_tr_b16 v[48:49], v4 offset:35840
    ds_read_b64_tr_b16 v[50:51], v4 offset:36864
    ds_read_b64_tr_b16 v[56:57], v5 offset:35840
    ds_read_b64_tr_b16 v[58:59], v5 offset:36864
    ds_read_b64_tr_b16 v[52:53], v4 offset:37888
    ds_read_b64_tr_b16 v[54:55], v4 offset:38912
    ds_read_b64_tr_b16 v[60:61], v5 offset:37888
    ds_read_b64_tr_b16 v[62:63], v5 offset:38912
    s_waitcnt vmcnt(15)
    s_waitcnt lgkmcnt(8)
    v_mfma_f32_32x32x16_bf16 v[16:31], v[64:67], a[72:75], v[16:31]
    s_add_u32 m0, s27, 57344
    s_add_u32 s24, s25, 401408
    buffer_load_dwordx4 v3, s[8:11], s24 offen lds
    v_mfma_f32_32x32x16_bf16 v[32:47], v[72:75], a[72:75], v[32:47]
    buffer_load_dwordx4 a[120:123], v2, s[12:15], s28 offen offset:2048
    v_mfma_f32_32x32x16_bf16 v[16:31], v[68:71], a[76:79], v[16:31]
    buffer_load_dwordx4 a[124:127], v2, s[12:15], s28 offen offset:3072
    v_mfma_f32_32x32x16_bf16 v[32:47], v[76:79], a[76:79], v[32:47]
    s_waitcnt vmcnt(14)
    s_barrier
    ds_read_b64_tr_b16 v[64:65], v4 offset:39424
    ds_read_b64_tr_b16 v[66:67], v4 offset:40448
    ds_read_b64_tr_b16 v[72:73], v5 offset:39424
    ds_read_b64_tr_b16 v[74:75], v5 offset:40448
    ds_read_b64_tr_b16 v[68:69], v4 offset:41472
    ds_read_b64_tr_b16 v[70:71], v4 offset:42496
    ds_read_b64_tr_b16 v[76:77], v5 offset:41472
    ds_read_b64_tr_b16 v[78:79], v5 offset:42496
    s_waitcnt vmcnt(15)
    s_waitcnt lgkmcnt(8)
    v_mfma_f32_32x32x16_bf16 v[16:31], v[48:51], a[80:83], v[16:31]
    v_mfma_f32_32x32x16_bf16 v[32:47], v[56:59], a[80:83], v[32:47]
    v_mfma_f32_32x32x16_bf16 v[16:31], v[52:55], a[84:87], v[16:31]
    v_mfma_f32_32x32x16_bf16 v[32:47], v[60:63], a[84:87], v[32:47]
    s_waitcnt vmcnt(11)
    s_barrier
    ds_read_b64_tr_b16 v[48:49], v4 offset:43008
    ds_read_b64_tr_b16 v[50:51], v4 offset:44032
    ds_read_b64_tr_b16 v[56:57], v5 offset:43008
    ds_read_b64_tr_b16 v[58:59], v5 offset:44032
    ds_read_b64_tr_b16 v[52:53], v4 offset:45056
    ds_read_b64_tr_b16 v[54:55], v4 offset:46080
    ds_read_b64_tr_b16 v[60:61], v5 offset:45056
    ds_read_b64_tr_b16 v[62:63], v5 offset:46080
    s_waitcnt vmcnt(12)
    s_waitcnt lgkmcnt(8)
    v_mfma_f32_32x32x16_bf16 v[16:31], v[64:67], a[88:91], v[16:31]
    v_mfma_f32_32x32x16_bf16 v[32:47], v[72:75], a[88:91], v[32:47]
    v_mfma_f32_32x32x16_bf16 v[16:31], v[68:71], a[92:95], v[16:31]
    v_mfma_f32_32x32x16_bf16 v[32:47], v[76:79], a[92:95], v[32:47]
    s_waitcnt vmcnt(8)
    s_barrier
    ds_read_b64_tr_b16 v[64:65], v4 offset:46592
    ds_read_b64_tr_b16 v[66:67], v4 offset:47616
    ds_read_b64_tr_b16 v[72:73], v5 offset:46592
    ds_read_b64_tr_b16 v[74:75], v5 offset:47616
    ds_read_b64_tr_b16 v[68:69], v4 offset:48640
    ds_read_b64_tr_b16 v[70:71], v4 offset:49664
    ds_read_b64_tr_b16 v[76:77], v5 offset:48640
    ds_read_b64_tr_b16 v[78:79], v5 offset:49664
    s_waitcnt vmcnt(9)
    s_waitcnt lgkmcnt(8)
    v_mfma_f32_32x32x16_bf16 v[16:31], v[48:51], a[96:99], v[16:31]
    v_mfma_f32_32x32x16_bf16 v[32:47], v[56:59], a[96:99], v[32:47]
    v_mfma_f32_32x32x16_bf16 v[16:31], v[52:55], a[100:103], v[16:31]
    v_mfma_f32_32x32x16_bf16 v[32:47], v[60:63], a[100:103], v[32:47]
    s_waitcnt vmcnt(5)
    s_barrier
    ds_read_b64_tr_b16 v[48:49], v4 offset:50176
    ds_read_b64_tr_b16 v[50:51], v4 offset:51200
    ds_read_b64_tr_b16 v[56:57], v5 offset:50176
    ds_read_b64_tr_b16 v[58:59], v5 offset:51200
    ds_read_b64_tr_b16 v[52:53], v4 offset:52224
    ds_read_b64_tr_b16 v[54:55], v4 offset:53248
    ds_read_b64_tr_b16 v[60:61], v5 offset:52224
    ds_read_b64_tr_b16 v[62:63], v5 offset:53248
    s_waitcnt vmcnt(6)
    s_waitcnt lgkmcnt(8)
    v_mfma_f32_32x32x16_bf16 v[16:31], v[64:67], a[104:107], v[16:31]
    v_mfma_f32_32x32x16_bf16 v[32:47], v[72:75], a[104:107], v[32:47]
    v_mfma_f32_32x32x16_bf16 v[16:31], v[68:71], a[108:111], v[16:31]
    v_mfma_f32_32x32x16_bf16 v[32:47], v[76:79], a[108:111], v[32:47]
    s_waitcnt vmcnt(2)
    s_barrier
    ds_read_b64_tr_b16 v[64:65], v4 offset:53760
    ds_read_b64_tr_b16 v[66:67], v4 offset:54784
    ds_read_b64_tr_b16 v[72:73], v5 offset:53760
    ds_read_b64_tr_b16 v[74:75], v5 offset:54784
    ds_read_b64_tr_b16 v[68:69], v4 offset:55808
    ds_read_b64_tr_b16 v[70:71], v4 offset:56832
    ds_read_b64_tr_b16 v[76:77], v5 offset:55808
    ds_read_b64_tr_b16 v[78:79], v5 offset:56832
    s_waitcnt vmcnt(3)
    s_waitcnt lgkmcnt(8)
    v_mfma_f32_32x32x16_bf16 v[16:31], v[48:51], a[112:115], v[16:31]
    v_mfma_f32_32x32x16_bf16 v[32:47], v[56:59], a[112:115], v[32:47]
    v_mfma_f32_32x32x16_bf16 v[16:31], v[52:55], a[116:119], v[16:31]
    v_mfma_f32_32x32x16_bf16 v[32:47], v[60:63], a[116:119], v[32:47]
    s_waitcnt vmcnt(0)
    s_waitcnt lgkmcnt(0)
    v_mfma_f32_32x32x16_bf16 v[16:31], v[64:67], a[120:123], v[16:31]
    v_mfma_f32_32x32x16_bf16 v[32:47], v[72:75], a[120:123], v[32:47]
    v_mfma_f32_32x32x16_bf16 v[16:31], v[68:71], a[124:127], v[16:31]
    v_mfma_f32_32x32x16_bf16 v[32:47], v[76:79], a[124:127], v[32:47]
    s_nop 10
    v_cvt_pk_bf16_f32 v48, v16, v17
    v_cvt_pk_bf16_f32 v49, v18, v19
    v_cvt_pk_bf16_f32 v50, v20, v21
    v_cvt_pk_bf16_f32 v51, v22, v23
    v_cvt_pk_bf16_f32 v52, v24, v25
    v_cvt_pk_bf16_f32 v53, v26, v27
    v_cvt_pk_bf16_f32 v54, v28, v29
    v_cvt_pk_bf16_f32 v55, v30, v31
    v_permlane32_swap_b32 v48, v50
    v_permlane32_swap_b32 v49, v51
    ds_write_b128 v8, v[48:51]
    v_permlane32_swap_b32 v52, v54
    v_permlane32_swap_b32 v53, v55
    ds_write_b128 v9, v[52:55]
    v_cvt_pk_bf16_f32 v56, v32, v33
    v_cvt_pk_bf16_f32 v57, v34, v35
    v_cvt_pk_bf16_f32 v58, v36, v37
    v_cvt_pk_bf16_f32 v59, v38, v39
    v_cvt_pk_bf16_f32 v60, v40, v41
    v_cvt_pk_bf16_f32 v61, v42, v43
    v_cvt_pk_bf16_f32 v62, v44, v45
    v_cvt_pk_bf16_f32 v63, v46, v47
    v_permlane32_swap_b32 v56, v58
    v_permlane32_swap_b32 v57, v59
    ds_write_b128 v10, v[56:59]
    v_permlane32_swap_b32 v60, v62
    v_permlane32_swap_b32 v61, v63
    ds_write_b128 v11, v[60:63]
    s_waitcnt lgkmcnt(0)
    ds_read_b128 v[16:19], v12 offset:0
    ds_read_b128 v[20:23], v12 offset:1024
    ds_read_b128 v[24:27], v12 offset:2048
    ds_read_b128 v[28:31], v12 offset:3072
    s_waitcnt lgkmcnt(3)
    buffer_store_dwordx4 v[16:19], v6, s[16:19], s22 offen sc1
    s_add_u32 s22, s22, 14336
    s_waitcnt lgkmcnt(2)
    buffer_store_dwordx4 v[20:23], v6, s[16:19], s22 offen sc1
    s_add_u32 s22, s22, 14336
    s_waitcnt lgkmcnt(1)
    buffer_store_dwordx4 v[24:27], v6, s[16:19], s22 offen sc1
    s_add_u32 s22, s22, 14336
    s_waitcnt lgkmcnt(0)
    buffer_store_dwordx4 v[28:31], v6, s[16:19], s22 offen sc1
L3_end:
    s_endpgm
L_code_end:
.section .rodata,"a"
.p2align 6
.amdhsa_kernel qkv_kernel
  .amdhsa_next_free_vgpr 216
  .amdhsa_next_free_sgpr 60
  .amdhsa_accum_offset 216
  .amdhsa_group_segment_fixed_size 0
  .amdhsa_kernarg_size 80
  .amdhsa_user_sgpr_count 2
  .amdhsa_user_sgpr_kernarg_segment_ptr 1
  .amdhsa_system_sgpr_workgroup_id_x 1
.end_amdhsa_kernel
.p2align 6
.amdhsa_kernel attn_kernel
  .amdhsa_next_free_vgpr 256
  .amdhsa_next_free_sgpr 52
  .amdhsa_accum_offset 128
  .amdhsa_group_segment_fixed_size 0
  .amdhsa_kernarg_size 80
  .amdhsa_user_sgpr_count 2
  .amdhsa_user_sgpr_kernarg_segment_ptr 1
  .amdhsa_system_sgpr_workgroup_id_x 1
.end_amdhsa_kernel
.p2align 6
.amdhsa_kernel oproj_kernel
  .amdhsa_next_free_vgpr 224
  .amdhsa_next_free_sgpr 32
  .amdhsa_accum_offset 96
  .amdhsa_group_segment_fixed_size 0
  .amdhsa_kernarg_size 80
  .amdhsa_user_sgpr_count 2
  .amdhsa_user_sgpr_kernarg_segment_ptr 1
  .amdhsa_system_sgpr_workgroup_id_x 1
.end_amdhsa_kernel
```
